```python
import torch

def _softmax(x, axis=-1):
    return torch.softmax(x, dim=axis)
def _gelu(x):
    return torch.nn.functional.gelu(x, approximate="tanh")
def _silu(x):
    return torch.nn.functional.silu(x)
def _sigmoid(x):
    return torch.sigmoid(x)
def _layernorm(x, axis=-1, eps=1e-5):
    m = x.mean(dim=axis, keepdim=True)
    v = x.var(dim=axis, keepdim=True, unbiased=False)
    return (x - m) / torch.sqrt(v + eps)
def _scatter_add(tgt, idx, src, axis=0):
    return tgt.clone().index_add_(axis, idx, src)
def _segment_sum(src, seg, n):
    out = torch.zeros((n,) + src.shape[1:], dtype=src.dtype)
    return out.index_add_(0, seg, src)
def _pad(x, pw):
    flat = tuple(v for pair in reversed(pw) for v in pair)
    return torch.nn.functional.pad(x, flat)

kernel_name = 'gated_mix__softmax_full_mha__swiglu_ffn__prompt'

def setup_inputs():

    _w = (lambda a: (lambda t: t.to(torch.bfloat16) if t.is_floating_point() else t)(torch.as_tensor(a)))
    def _A_setup():
        B, S, D = 1, 2048, 512
        return {
            "x": _w((lambda *s: torch.randn(*s, dtype=torch.bfloat16) * 0.05)(B, S, D)),
            "wqkv": _w((lambda *s: torch.randn(*s, dtype=torch.bfloat16) * 0.8)(D, 3 * D)),
            "wo": _w((lambda *s: torch.randn(*s, dtype=torch.bfloat16) * 0.05)(D, D)),
        }
    _A_in = _A_setup()

    def _B_setup():
        B, S, D, F = 1, 2048, 512, 1792
        return {
            "x": _w((lambda *s: torch.randn(*s, dtype=torch.bfloat16) * 0.05)(B, S, D)),
            "w_gate": _w((lambda *s: torch.randn(*s, dtype=torch.bfloat16) * 0.1)(D, F)),
            "w_up": _w((lambda *s: torch.randn(*s, dtype=torch.bfloat16) * 0.1)(D, F)),
            "w_down": _w((lambda *s: torch.randn(*s, dtype=torch.bfloat16) * 0.1)(F, D)),
        }
    _B_in = _B_setup()

    return {
        "A_x": _A_in["x"],
        "A_wqkv": _A_in["wqkv"],
        "A_wo": _A_in["wo"],
        "B_x": _B_in["x"],
        "B_w_gate": _B_in["w_gate"],
        "B_w_up": _B_in["w_up"],
        "B_w_down": _B_in["w_down"],
        "gate_w": _w((lambda *s: torch.randn(*s, dtype=torch.bfloat16) * 0.05)(512) * 16.0),
    }

def reference(A_x, A_wqkv, A_wo, B_x, B_w_gate, B_w_up, B_w_down, gate_w):
    def _A_ref(x, wqkv, wo):
        B, S, D = x.shape
        H = 32; Dh = D // H
        qkv = (lambda x, *d: x.permute(*d))((x @ wqkv).reshape(B, S, 3, H, Dh), 2, 0, 3, 1, 4)
        q, k, v = qkv[0], qkv[1], qkv[2]
        scale = Dh ** -0.5
        scores = torch.einsum("bhqd,bhkd->bhqk", q, k) * scale
        p = _softmax(scores, axis=-1)
        o = torch.einsum("bhqk,bhkd->bhqd", p, v)
        return (lambda x, *d: x.permute(*d))(o, 0, 2, 1, 3).reshape(B, S, D) @ wo

    def _B_ref(x, w_gate, w_up, w_down):
        g = _silu(x @ w_gate)
        u = x @ w_up
        return (g * u) @ w_down

    x = A_x
    g = _sigmoid((x * gate_w).sum(-1, keepdims=True))
    a = _A_ref(x, A_wqkv, A_wo)
    b = _B_ref(x, B_w_gate, B_w_up, B_w_down)
    return g * a + (1 - g) * b
```

```asm
; @launch grid=(512,1,1) block=(512,1,1) lds=81920
.amdgcn_target "amdgcn-amd-amdhsa--gfx950"
.text
.globl gated_mix__softmax_full_mha__swiglu_ffn__prompt_kernel
.p2align 8
.type gated_mix__softmax_full_mha__swiglu_ffn__prompt_kernel,@function
gated_mix__softmax_full_mha__swiglu_ffn__prompt_kernel:
CODE_START:
    s_cmp_ge_u32 s2, 256
    s_cbranch_scc1 F_entry
    s_load_dwordx2 s[12:13], s[0:1], 0
    s_load_dwordx2 s[16:17], s[0:1], 8
    s_load_dwordx2 s[24:25], s[0:1], 80
    s_load_dwordx2 s[28:29], s[0:1], 72
    v_lshrrev_b32 v8, 6, v0
    v_lshrrev_b32 v9, 3, v0
    v_lshrrev_b32 v10, 4, v0
    v_readfirstlane_b32 s3, v8
    v_xor_b32 v11, v10, v0
    v_and_b32 v11, 7, v11
    v_lshlrev_b32 v11, 4, v11
    v_lshl_add_u32 v1, v9, 10, v11
    s_mov_b32 s14, 0x200000
    s_mov_b32 s15, 0x20000
    s_mov_b32 s18, 0x180000
    s_mov_b32 s19, 0x20000
    s_lshr_b32 s50, s2, 3
    s_and_b32 s51, s50, 7
    s_lshr_b32 s50, s50, 3
    s_and_b32 s59, s2, 6
    s_lshl_b32 s59, s59, 2
    s_add_u32 s59, s59, s51
    s_and_b32 s60, s2, 1
    s_lshl_b32 s60, s60, 2
    s_add_u32 s60, s60, s50
    s_lshl_b32 s50, s50, 1
    s_add_u32 s50, s50, s51
    s_and_b32 s50, s50, 7
    s_lshl_b32 s54, s50, 7
    s_mul_i32 s56, s50, 196608
    s_lshl_b32 s55, s59, 16
    s_lshl_b32 s57, s60, 7
    s_lshl_b32 s49, s3, 10
    v_and_b32 v9, 31, v9
    v_mul_u32_u24 v9, 0xc00, v9
    v_and_b32 v10, 1, v10
    v_lshlrev_b32 v10, 2, v10
    v_xor_b32 v10, v10, v0
    v_and_b32 v10, 7, v10
    v_lshl_add_u32 v9, v10, 4, v9
    v_lshrrev_b32 v10, 8, v0
    v_lshl_add_u32 v2, v10, 10, v9
    v_cmp_eq_u32 vcc, 1, v10
    s_setprio 3
    s_waitcnt lgkmcnt(0)
    s_add_u32 m0, s49, 0
    s_add_u32 s50, s55, s54
    buffer_load_dwordx4 v1, s[12:15], s50 offen lds
    s_add_u32 s54, s54, 128
    s_and_b32 s54, s54, 1023
    s_add_u32 m0, s49, 24576
    s_add_u32 s50, s57, s56
    buffer_load_dwordx4 v2, s[16:19], s50 offen lds
    s_cbranch_vccz A_pw0
    s_add_u32 m0, s49, 27648
    s_nop 0
    buffer_load_dwordx4 v2, s[16:19], s50 offen offset:1024 lds
A_pw0:
    s_add_u32 s56, s56, 98304
    s_cmp_eq_u32 s56, 1572864
    s_cselect_b32 s56, 0, s56
    s_add_u32 m0, s49, 36864
    s_add_u32 s50, s57, s56
    buffer_load_dwordx4 v2, s[16:19], s50 offen lds
    s_cbranch_vccz A_pw1
    s_add_u32 m0, s49, 39936
    s_nop 0
    buffer_load_dwordx4 v2, s[16:19], s50 offen offset:1024 lds
A_pw1:
    s_add_u32 s56, s56, 98304
    s_cmp_eq_u32 s56, 1572864
    s_cselect_b32 s56, 0, s56
    s_add_u32 m0, s49, 8192
    s_add_u32 s50, s55, s54
    buffer_load_dwordx4 v1, s[12:15], s50 offen lds
    s_add_u32 s54, s54, 128
    s_and_b32 s54, s54, 1023
    s_add_u32 m0, s49, 49152
    s_add_u32 s50, s57, s56
    buffer_load_dwordx4 v2, s[16:19], s50 offen lds
    s_cbranch_vccz A_pw2
    s_add_u32 m0, s49, 52224
    s_nop 0
    buffer_load_dwordx4 v2, s[16:19], s50 offen offset:1024 lds
A_pw2:
    s_add_u32 s56, s56, 98304
    s_cmp_eq_u32 s56, 1572864
    s_cselect_b32 s56, 0, s56
    s_add_u32 m0, s49, 61440
    s_add_u32 s50, s57, s56
    buffer_load_dwordx4 v2, s[16:19], s50 offen lds
    s_cbranch_vccz A_pw3
    s_add_u32 m0, s49, 64512
    s_nop 0
    buffer_load_dwordx4 v2, s[16:19], s50 offen offset:1024 lds
A_pw3:
    s_add_u32 s56, s56, 98304
    s_cmp_eq_u32 s56, 1572864
    s_cselect_b32 s56, 0, s56
    s_add_u32 m0, s49, 16384
    s_add_u32 s50, s55, s54
    buffer_load_dwordx4 v1, s[12:15], s50 offen lds
    s_add_u32 s54, s54, 128
    s_and_b32 s54, s54, 1023
    s_mov_b32 s26, 0x1100000
    s_mov_b32 s27, 0x20000
    s_mov_b32 s30, 0x100
    s_mov_b32 s31, 0x20000
    s_cbranch_vccnz A_vwave
    s_branch A_qwave
F_entry:
    s_cmp_ge_u32 s2, 512
    s_cbranch_scc1 L_end
    s_load_dwordx2 s[12:13], s[0:1], 0
    s_load_dwordx2 s[16:17], s[0:1], 32
    s_load_dwordx2 s[20:21], s[0:1], 40
    s_load_dwordx2 s[24:25], s[0:1], 80
    s_load_dwordx2 s[28:29], s[0:1], 72
    s_load_dwordx2 s[32:33], s[0:1], 48
    s_load_dwordx2 s[36:37], s[0:1], 16
    s_load_dwordx2 s[40:41], s[0:1], 64
    s_load_dwordx2 s[44:45], s[0:1], 56
    v_lshrrev_b32 v8, 6, v0
    s_bfe_u32 s61, s2, 0x50003
    v_readfirstlane_b32 s3, v8
    s_getpc_b64 s[4:5]
F_pc:
    s_add_u32 s4, s4, CODE_START - F_pc
    s_addc_u32 s5, s5, -1
    s_mov_b32 s6, CODE_END - CODE_START
    s_mov_b32 s7, 0x20000
    s_lshl_b32 s50, s61, 10
    s_lshl_b32 s51, s3, 7
    s_add_u32 s50, s50, s51
    v_mov_b32 v9, 0
    s_mov_b64 exec, 1
    buffer_load_dword v120, v9, s[4:7], s50 offen
    s_mov_b64 exec, -1
    s_branch F_main
L_end:
    s_endpgm
A_qwave:
    v_and_b32 v8, 31, v0
    v_lshrrev_b32 v9, 1, v8
    v_and_b32 v9, 7, v9
    v_bfe_u32 v10, v0, 5, 1
    v_xor_b32 v9, v9, v10
    v_lshlrev_b32 v9, 4, v9
    v_lshl_add_u32 v9, v8, 7, v9
    v_bfe_u32 v8, v0, 6, 1
    v_lshl_add_u32 v3, v8, 12, v9
    v_xor_b32 v4, 32, v3
    v_xor_b32 v5, 64, v3
    v_xor_b32 v6, 96, v3
    v_bfe_u32 v8, v0, 2, 2
    v_lshl_add_u32 v9, v10, 3, v8
    v_lshlrev_b32 v9, 7, v9
    v_bfe_u32 v10, v0, 7, 1
    v_lshrrev_b32 v8, 1, v8
    v_xor_b32 v8, v8, v10
    v_lshl_add_u32 v9, v8, 6, v9
    v_bfe_u32 v8, v0, 4, 1
    v_lshl_add_u32 v9, v8, 5, v9
    v_and_b32 v8, 3, v0
    v_lshl_add_u32 v9, v8, 3, v9
    v_add_u32 v7, 24576, v9
    s_or_b32 s50, s2, s3
    s_cbranch_scc1 A_notag
    s_memrealtime s[50:51]
    s_waitcnt lgkmcnt(0)
    s_or_b32 s50, s50, 1
    s_mov_b64 exec, 1
    v_mov_b32 v10, 0
    v_mov_b32 v11, s50
    buffer_store_dword v11, v10, s[28:31], 0 offen sc0 sc1
    s_mov_b64 exec, -1
A_notag:
    s_waitcnt vmcnt(5) lgkmcnt(0)
    s_barrier
    ds_read_b128 v[16:19], v3 offset:0
    ds_read_b64_tr_b16 v[24:25], v7 offset:0
    ds_read_b64_tr_b16 v[26:27], v7 offset:512
    ds_read_b64_tr_b16 v[32:33], v7 offset:4096
    ds_read_b64_tr_b16 v[34:35], v7 offset:4608
    ds_read_b128 v[20:23], v4 offset:0
    ds_read_b64_tr_b16 v[28:29], v7 offset:2048
    ds_read_b64_tr_b16 v[30:31], v7 offset:2560
    ds_read_b64_tr_b16 v[36:37], v7 offset:6144
    ds_read_b64_tr_b16 v[38:39], v7 offset:6656
    s_waitcnt vmcnt(4) lgkmcnt(0)
    s_barrier
    v_mfma_f32_32x32x16_bf16 v[64:79], v[24:27], v[16:19], 0
    ds_read_b128 v[40:43], v5 offset:0
    ds_read_b64_tr_b16 v[48:49], v7 offset:12288
    ds_read_b64_tr_b16 v[50:51], v7 offset:12800
    v_mfma_f32_32x32x16_bf16 v[80:95], v[32:35], v[16:19], 0
    ds_read_b64_tr_b16 v[56:57], v7 offset:16384
    ds_read_b64_tr_b16 v[58:59], v7 offset:16896
    ds_read_b128 v[44:47], v6 offset:0
    v_mfma_f32_32x32x16_bf16 v[64:79], v[28:31], v[20:23], v[64:79]
    ds_read_b64_tr_b16 v[52:53], v7 offset:14336
    ds_read_b64_tr_b16 v[54:55], v7 offset:14848
    ds_read_b64_tr_b16 v[60:61], v7 offset:18432
    v_mfma_f32_32x32x16_bf16 v[80:95], v[36:39], v[20:23], v[80:95]
    ds_read_b64_tr_b16 v[62:63], v7 offset:18944
    s_add_u32 m0, s49, 24576
    s_add_u32 s50, s57, s56
    buffer_load_dwordx4 v2, s[16:19], s50 offen lds
    s_add_u32 s56, s56, 98304
    s_cmp_eq_u32 s56, 1572864
    s_cselect_b32 s56, 0, s56
    s_waitcnt vmcnt(3) lgkmcnt(0)
    s_barrier
    v_mfma_f32_32x32x16_bf16 v[64:79], v[48:51], v[40:43], v[64:79]
    ds_read_b128 v[16:19], v3 offset:8192
    ds_read_b64_tr_b16 v[24:25], v7 offset:24576
    ds_read_b64_tr_b16 v[26:27], v7 offset:25088
    v_mfma_f32_32x32x16_bf16 v[80:95], v[56:59], v[40:43], v[80:95]
    ds_read_b64_tr_b16 v[32:33], v7 offset:28672
    ds_read_b64_tr_b16 v[34:35], v7 offset:29184
    ds_read_b128 v[20:23], v4 offset:8192
    v_mfma_f32_32x32x16_bf16 v[64:79], v[52:55], v[44:47], v[64:79]
    ds_read_b64_tr_b16 v[28:29], v7 offset:26624
    ds_read_b64_tr_b16 v[30:31], v7 offset:27136
    ds_read_b64_tr_b16 v[36:37], v7 offset:30720
    v_mfma_f32_32x32x16_bf16 v[80:95], v[60:63], v[44:47], v[80:95]
    ds_read_b64_tr_b16 v[38:39], v7 offset:31232
    s_add_u32 m0, s49, 36864
    s_add_u32 s50, s57, s56
    buffer_load_dwordx4 v2, s[16:19], s50 offen lds
    s_add_u32 s56, s56, 98304
    s_cmp_eq_u32 s56, 1572864
    s_cselect_b32 s56, 0, s56
    s_add_u32 m0, s49, 0
    s_add_u32 s50, s55, s54
    buffer_load_dwordx4 v1, s[12:15], s50 offen lds
    s_add_u32 s54, s54, 128
    s_and_b32 s54, s54, 1023
    v_mov_b32 v10, 0
    buffer_load_dword v14, v10, s[28:31], 0 offen sc1
    s_waitcnt vmcnt(5) lgkmcnt(0)
    s_barrier
    v_mfma_f32_32x32x16_bf16 v[64:79], v[24:27], v[16:19], v[64:79]
    ds_read_b128 v[40:43], v5 offset:8192
    ds_read_b64_tr_b16 v[48:49], v7 offset:36864
    ds_read_b64_tr_b16 v[50:51], v7 offset:37376
    v_mfma_f32_32x32x16_bf16 v[80:95], v[32:35], v[16:19], v[80:95]
    ds_read_b64_tr_b16 v[56:57], v7 offset:40960
    ds_read_b64_tr_b16 v[58:59], v7 offset:41472
    ds_read_b128 v[44:47], v6 offset:8192
    v_mfma_f32_32x32x16_bf16 v[64:79], v[28:31], v[20:23], v[64:79]
    ds_read_b64_tr_b16 v[52:53], v7 offset:38912
    ds_read_b64_tr_b16 v[54:55], v7 offset:39424
    ds_read_b64_tr_b16 v[60:61], v7 offset:43008
    v_mfma_f32_32x32x16_bf16 v[80:95], v[36:39], v[20:23], v[80:95]
    ds_read_b64_tr_b16 v[62:63], v7 offset:43520
    s_add_u32 m0, s49, 49152
    s_add_u32 s50, s57, s56
    buffer_load_dwordx4 v2, s[16:19], s50 offen lds
    s_add_u32 s56, s56, 98304
    s_cmp_eq_u32 s56, 1572864
    s_cselect_b32 s56, 0, s56
    s_waitcnt vmcnt(4) lgkmcnt(0)
    s_barrier
    v_mfma_f32_32x32x16_bf16 v[64:79], v[48:51], v[40:43], v[64:79]
    ds_read_b128 v[16:19], v3 offset:16384
    ds_read_b64_tr_b16 v[24:25], v7 offset:0
    ds_read_b64_tr_b16 v[26:27], v7 offset:512
    v_mfma_f32_32x32x16_bf16 v[80:95], v[56:59], v[40:43], v[80:95]
    ds_read_b64_tr_b16 v[32:33], v7 offset:4096
    ds_read_b64_tr_b16 v[34:35], v7 offset:4608
    ds_read_b128 v[20:23], v4 offset:16384
    v_mfma_f32_32x32x16_bf16 v[64:79], v[52:55], v[44:47], v[64:79]
    ds_read_b64_tr_b16 v[28:29], v7 offset:2048
    ds_read_b64_tr_b16 v[30:31], v7 offset:2560
    ds_read_b64_tr_b16 v[36:37], v7 offset:6144
    v_mfma_f32_32x32x16_bf16 v[80:95], v[60:63], v[44:47], v[80:95]
    ds_read_b64_tr_b16 v[38:39], v7 offset:6656
    s_add_u32 m0, s49, 61440
    s_add_u32 s50, s57, s56
    buffer_load_dwordx4 v2, s[16:19], s50 offen lds
    s_add_u32 s56, s56, 98304
    s_cmp_eq_u32 s56, 1572864
    s_cselect_b32 s56, 0, s56
    s_add_u32 m0, s49, 8192
    s_add_u32 s50, s55, s54
    buffer_load_dwordx4 v1, s[12:15], s50 offen lds
    s_add_u32 s54, s54, 128
    s_and_b32 s54, s54, 1023
    s_waitcnt vmcnt(5) lgkmcnt(0)
    s_barrier
    v_mfma_f32_32x32x16_bf16 v[64:79], v[24:27], v[16:19], v[64:79]
    ds_read_b128 v[40:43], v5 offset:16384
    ds_read_b64_tr_b16 v[48:49], v7 offset:12288
    ds_read_b64_tr_b16 v[50:51], v7 offset:12800
    v_mfma_f32_32x32x16_bf16 v[80:95], v[32:35], v[16:19], v[80:95]
    ds_read_b64_tr_b16 v[56:57], v7 offset:16384
    ds_read_b64_tr_b16 v[58:59], v7 offset:16896
    ds_read_b128 v[44:47], v6 offset:16384
    v_mfma_f32_32x32x16_bf16 v[64:79], v[28:31], v[20:23], v[64:79]
    ds_read_b64_tr_b16 v[52:53], v7 offset:14336
    ds_read_b64_tr_b16 v[54:55], v7 offset:14848
    ds_read_b64_tr_b16 v[60:61], v7 offset:18432
    v_mfma_f32_32x32x16_bf16 v[80:95], v[36:39], v[20:23], v[80:95]
    ds_read_b64_tr_b16 v[62:63], v7 offset:18944
    s_add_u32 m0, s49, 24576
    s_add_u32 s50, s57, s56
    buffer_load_dwordx4 v2, s[16:19], s50 offen lds
    s_add_u32 s56, s56, 98304
    s_cmp_eq_u32 s56, 1572864
    s_cselect_b32 s56, 0, s56
    s_waitcnt vmcnt(3) lgkmcnt(0)
    s_barrier
    v_mfma_f32_32x32x16_bf16 v[64:79], v[48:51], v[40:43], v[64:79]
    ds_read_b128 v[16:19], v3 offset:0
    ds_read_b64_tr_b16 v[24:25], v7 offset:24576
    ds_read_b64_tr_b16 v[26:27], v7 offset:25088
    v_mfma_f32_32x32x16_bf16 v[80:95], v[56:59], v[40:43], v[80:95]
    ds_read_b64_tr_b16 v[32:33], v7 offset:28672
    ds_read_b64_tr_b16 v[34:35], v7 offset:29184
    ds_read_b128 v[20:23], v4 offset:0
    v_mfma_f32_32x32x16_bf16 v[64:79], v[52:55], v[44:47], v[64:79]
    ds_read_b64_tr_b16 v[28:29], v7 offset:26624
    ds_read_b64_tr_b16 v[30:31], v7 offset:27136
    ds_read_b64_tr_b16 v[36:37], v7 offset:30720
    v_mfma_f32_32x32x16_bf16 v[80:95], v[60:63], v[44:47], v[80:95]
    ds_read_b64_tr_b16 v[38:39], v7 offset:31232
    s_add_u32 m0, s49, 36864
    s_add_u32 s50, s57, s56
    buffer_load_dwordx4 v2, s[16:19], s50 offen lds
    s_add_u32 s56, s56, 98304
    s_cmp_eq_u32 s56, 1572864
    s_cselect_b32 s56, 0, s56
    s_add_u32 m0, s49, 16384
    s_add_u32 s50, s55, s54
    buffer_load_dwordx4 v1, s[12:15], s50 offen lds
    s_add_u32 s54, s54, 128
    s_and_b32 s54, s54, 1023
    s_waitcnt vmcnt(4) lgkmcnt(0)
    s_barrier
    v_mfma_f32_32x32x16_bf16 v[64:79], v[24:27], v[16:19], v[64:79]
    ds_read_b128 v[40:43], v5 offset:0
    ds_read_b64_tr_b16 v[48:49], v7 offset:36864
    ds_read_b64_tr_b16 v[50:51], v7 offset:37376
    v_mfma_f32_32x32x16_bf16 v[80:95], v[32:35], v[16:19], v[80:95]
    ds_read_b64_tr_b16 v[56:57], v7 offset:40960
    ds_read_b64_tr_b16 v[58:59], v7 offset:41472
    ds_read_b128 v[44:47], v6 offset:0
    v_mfma_f32_32x32x16_bf16 v[64:79], v[28:31], v[20:23], v[64:79]
    ds_read_b64_tr_b16 v[52:53], v7 offset:38912
    ds_read_b64_tr_b16 v[54:55], v7 offset:39424
    ds_read_b64_tr_b16 v[60:61], v7 offset:43008
    v_mfma_f32_32x32x16_bf16 v[80:95], v[36:39], v[20:23], v[80:95]
    ds_read_b64_tr_b16 v[62:63], v7 offset:43520
    s_add_u32 m0, s49, 49152
    s_add_u32 s50, s57, s56
    buffer_load_dwordx4 v2, s[16:19], s50 offen lds
    s_add_u32 s56, s56, 98304
    s_cmp_eq_u32 s56, 1572864
    s_cselect_b32 s56, 0, s56
    s_waitcnt vmcnt(3) lgkmcnt(0)
    s_barrier
    v_mfma_f32_32x32x16_bf16 v[64:79], v[48:51], v[40:43], v[64:79]
    ds_read_b128 v[16:19], v3 offset:8192
    ds_read_b64_tr_b16 v[24:25], v7 offset:0
    ds_read_b64_tr_b16 v[26:27], v7 offset:512
    v_mfma_f32_32x32x16_bf16 v[80:95], v[56:59], v[40:43], v[80:95]
    ds_read_b64_tr_b16 v[32:33], v7 offset:4096
    ds_read_b64_tr_b16 v[34:35], v7 offset:4608
    ds_read_b128 v[20:23], v4 offset:8192
    v_mfma_f32_32x32x16_bf16 v[64:79], v[52:55], v[44:47], v[64:79]
    ds_read_b64_tr_b16 v[28:29], v7 offset:2048
    ds_read_b64_tr_b16 v[30:31], v7 offset:2560
    ds_read_b64_tr_b16 v[36:37], v7 offset:6144
    v_mfma_f32_32x32x16_bf16 v[80:95], v[60:63], v[44:47], v[80:95]
    ds_read_b64_tr_b16 v[38:39], v7 offset:6656
    s_add_u32 m0, s49, 61440
    s_add_u32 s50, s57, s56
    buffer_load_dwordx4 v2, s[16:19], s50 offen lds
    s_add_u32 s56, s56, 98304
    s_cmp_eq_u32 s56, 1572864
    s_cselect_b32 s56, 0, s56
    s_add_u32 m0, s49, 0
    s_add_u32 s50, s55, s54
    buffer_load_dwordx4 v1, s[12:15], s50 offen lds
    s_add_u32 s54, s54, 128
    s_and_b32 s54, s54, 1023
    s_waitcnt vmcnt(4) lgkmcnt(0)
    s_barrier
    v_mfma_f32_32x32x16_bf16 v[64:79], v[24:27], v[16:19], v[64:79]
    ds_read_b128 v[40:43], v5 offset:8192
    ds_read_b64_tr_b16 v[48:49], v7 offset:12288
    ds_read_b64_tr_b16 v[50:51], v7 offset:12800
    v_mfma_f32_32x32x16_bf16 v[80:95], v[32:35], v[16:19], v[80:95]
    ds_read_b64_tr_b16 v[56:57], v7 offset:16384
    ds_read_b64_tr_b16 v[58:59], v7 offset:16896
    ds_read_b128 v[44:47], v6 offset:8192
    v_mfma_f32_32x32x16_bf16 v[64:79], v[28:31], v[20:23], v[64:79]
    ds_read_b64_tr_b16 v[52:53], v7 offset:14336
    ds_read_b64_tr_b16 v[54:55], v7 offset:14848
    ds_read_b64_tr_b16 v[60:61], v7 offset:18432
    v_mfma_f32_32x32x16_bf16 v[80:95], v[36:39], v[20:23], v[80:95]
    ds_read_b64_tr_b16 v[62:63], v7 offset:18944
    s_add_u32 m0, s49, 24576
    s_add_u32 s50, s57, s56
    buffer_load_dwordx4 v2, s[16:19], s50 offen lds
    s_add_u32 s56, s56, 98304
    s_cmp_eq_u32 s56, 1572864
    s_cselect_b32 s56, 0, s56
    s_waitcnt vmcnt(3) lgkmcnt(0)
    s_barrier
    v_mfma_f32_32x32x16_bf16 v[64:79], v[48:51], v[40:43], v[64:79]
    ds_read_b128 v[16:19], v3 offset:16384
    ds_read_b64_tr_b16 v[24:25], v7 offset:24576
    ds_read_b64_tr_b16 v[26:27], v7 offset:25088
    v_mfma_f32_32x32x16_bf16 v[80:95], v[56:59], v[40:43], v[80:95]
    ds_read_b64_tr_b16 v[32:33], v7 offset:28672
    ds_read_b64_tr_b16 v[34:35], v7 offset:29184
    ds_read_b128 v[20:23], v4 offset:16384
    v_mfma_f32_32x32x16_bf16 v[64:79], v[52:55], v[44:47], v[64:79]
    ds_read_b64_tr_b16 v[28:29], v7 offset:26624
    ds_read_b64_tr_b16 v[30:31], v7 offset:27136
    ds_read_b64_tr_b16 v[36:37], v7 offset:30720
    v_mfma_f32_32x32x16_bf16 v[80:95], v[60:63], v[44:47], v[80:95]
    ds_read_b64_tr_b16 v[38:39], v7 offset:31232
    s_add_u32 m0, s49, 36864
    s_add_u32 s50, s57, s56
    buffer_load_dwordx4 v2, s[16:19], s50 offen lds
    s_add_u32 s56, s56, 98304
    s_cmp_eq_u32 s56, 1572864
    s_cselect_b32 s56, 0, s56
    s_add_u32 m0, s49, 8192
    s_add_u32 s50, s55, s54
    buffer_load_dwordx4 v1, s[12:15], s50 offen lds
    s_add_u32 s54, s54, 128
    s_and_b32 s54, s54, 1023
    s_waitcnt vmcnt(4) lgkmcnt(0)
    s_barrier
    v_mfma_f32_32x32x16_bf16 v[64:79], v[24:27], v[16:19], v[64:79]
    ds_read_b128 v[40:43], v5 offset:16384
    ds_read_b64_tr_b16 v[48:49], v7 offset:36864
    ds_read_b64_tr_b16 v[50:51], v7 offset:37376
    v_mfma_f32_32x32x16_bf16 v[80:95], v[32:35], v[16:19], v[80:95]
    ds_read_b64_tr_b16 v[56:57], v7 offset:40960
    ds_read_b64_tr_b16 v[58:59], v7 offset:41472
    ds_read_b128 v[44:47], v6 offset:16384
    v_mfma_f32_32x32x16_bf16 v[64:79], v[28:31], v[20:23], v[64:79]
    ds_read_b64_tr_b16 v[52:53], v7 offset:38912
    ds_read_b64_tr_b16 v[54:55], v7 offset:39424
    ds_read_b64_tr_b16 v[60:61], v7 offset:43008
    v_mfma_f32_32x32x16_bf16 v[80:95], v[36:39], v[20:23], v[80:95]
    ds_read_b64_tr_b16 v[62:63], v7 offset:43520
    s_add_u32 m0, s49, 49152
    s_add_u32 s50, s57, s56
    buffer_load_dwordx4 v2, s[16:19], s50 offen lds
    s_add_u32 s56, s56, 98304
    s_cmp_eq_u32 s56, 1572864
    s_cselect_b32 s56, 0, s56
    s_waitcnt vmcnt(3) lgkmcnt(0)
    s_barrier
    v_mfma_f32_32x32x16_bf16 v[64:79], v[48:51], v[40:43], v[64:79]
    ds_read_b128 v[16:19], v3 offset:0
    ds_read_b64_tr_b16 v[24:25], v7 offset:0
    ds_read_b64_tr_b16 v[26:27], v7 offset:512
    v_mfma_f32_32x32x16_bf16 v[80:95], v[56:59], v[40:43], v[80:95]
    ds_read_b64_tr_b16 v[32:33], v7 offset:4096
    ds_read_b64_tr_b16 v[34:35], v7 offset:4608
    ds_read_b128 v[20:23], v4 offset:0
    v_mfma_f32_32x32x16_bf16 v[64:79], v[52:55], v[44:47], v[64:79]
    ds_read_b64_tr_b16 v[28:29], v7 offset:2048
    ds_read_b64_tr_b16 v[30:31], v7 offset:2560
    ds_read_b64_tr_b16 v[36:37], v7 offset:6144
    v_mfma_f32_32x32x16_bf16 v[80:95], v[60:63], v[44:47], v[80:95]
    ds_read_b64_tr_b16 v[38:39], v7 offset:6656
    s_add_u32 m0, s49, 61440
    s_add_u32 s50, s57, s56
    buffer_load_dwordx4 v2, s[16:19], s50 offen lds
    s_add_u32 s56, s56, 98304
    s_cmp_eq_u32 s56, 1572864
    s_cselect_b32 s56, 0, s56
    s_lshr_b32 s50, s2, 3
    s_or_b32 s50, s50, s3
    s_cbranch_scc1 A_nohint1
    v_readfirstlane_b32 s48, v14
    s_nop 3
    s_cmp_lg_u32 s48, 0
    s_cbranch_scc1 A_nohint1_t_ok
    s_mov_b32 s66, 0x40000
    v_mov_b32 v10, 0
A_nohint1_t:
    buffer_load_dword v11, v10, s[28:31], 0 offen sc1
    s_waitcnt vmcnt(0)
    v_readfirstlane_b32 s48, v11
    s_nop 3
    s_cmp_lg_u32 s48, 0
    s_cbranch_scc1 A_nohint1_t_ok
    s_sleep 4
    s_sub_u32 s66, s66, 1
    s_cmp_lg_u32 s66, 0
    s_cbranch_scc1 A_nohint1_t
A_nohint1_t_ok:
    s_lshl_b32 s51, s2, 7
    s_add_u32 s51, s51, 0xf07400
    s_mov_b64 exec, 1
    v_mov_b32 v10, 0
    v_mov_b32 v11, s48
    buffer_store_dword v11, v10, s[24:27], s51 offen sc0 sc1
    s_mov_b64 exec, -1
A_nohint1:
    s_waitcnt vmcnt(3) lgkmcnt(0)
    s_barrier
    v_mfma_f32_32x32x16_bf16 v[64:79], v[24:27], v[16:19], v[64:79]
    ds_read_b128 v[40:43], v5 offset:0
    ds_read_b64_tr_b16 v[48:49], v7 offset:12288
    ds_read_b64_tr_b16 v[50:51], v7 offset:12800
    v_mfma_f32_32x32x16_bf16 v[80:95], v[32:35], v[16:19], v[80:95]
    ds_read_b64_tr_b16 v[56:57], v7 offset:16384
    ds_read_b64_tr_b16 v[58:59], v7 offset:16896
    ds_read_b128 v[44:47], v6 offset:0
    v_mfma_f32_32x32x16_bf16 v[64:79], v[28:31], v[20:23], v[64:79]
    ds_read_b64_tr_b16 v[52:53], v7 offset:14336
    ds_read_b64_tr_b16 v[54:55], v7 offset:14848
    ds_read_b64_tr_b16 v[60:61], v7 offset:18432
    v_mfma_f32_32x32x16_bf16 v[80:95], v[36:39], v[20:23], v[80:95]
    ds_read_b64_tr_b16 v[62:63], v7 offset:18944
    s_waitcnt vmcnt(1) lgkmcnt(0)
    s_barrier
    v_mfma_f32_32x32x16_bf16 v[64:79], v[48:51], v[40:43], v[64:79]
    ds_read_b128 v[16:19], v3 offset:8192
    ds_read_b64_tr_b16 v[24:25], v7 offset:24576
    ds_read_b64_tr_b16 v[26:27], v7 offset:25088
    v_mfma_f32_32x32x16_bf16 v[80:95], v[56:59], v[40:43], v[80:95]
    ds_read_b64_tr_b16 v[32:33], v7 offset:28672
    ds_read_b64_tr_b16 v[34:35], v7 offset:29184
    ds_read_b128 v[20:23], v4 offset:8192
    v_mfma_f32_32x32x16_bf16 v[64:79], v[52:55], v[44:47], v[64:79]
    ds_read_b64_tr_b16 v[28:29], v7 offset:26624
    ds_read_b64_tr_b16 v[30:31], v7 offset:27136
    ds_read_b64_tr_b16 v[36:37], v7 offset:30720
    v_mfma_f32_32x32x16_bf16 v[80:95], v[60:63], v[44:47], v[80:95]
    ds_read_b64_tr_b16 v[38:39], v7 offset:31232
    s_waitcnt vmcnt(0) lgkmcnt(0)
    s_barrier
    v_mfma_f32_32x32x16_bf16 v[64:79], v[24:27], v[16:19], v[64:79]
    ds_read_b128 v[40:43], v5 offset:8192
    ds_read_b64_tr_b16 v[48:49], v7 offset:36864
    ds_read_b64_tr_b16 v[50:51], v7 offset:37376
    v_mfma_f32_32x32x16_bf16 v[80:95], v[32:35], v[16:19], v[80:95]
    ds_read_b64_tr_b16 v[56:57], v7 offset:40960
    ds_read_b64_tr_b16 v[58:59], v7 offset:41472
    ds_read_b128 v[44:47], v6 offset:8192
    v_mfma_f32_32x32x16_bf16 v[64:79], v[28:31], v[20:23], v[64:79]
    ds_read_b64_tr_b16 v[52:53], v7 offset:38912
    ds_read_b64_tr_b16 v[54:55], v7 offset:39424
    ds_read_b64_tr_b16 v[60:61], v7 offset:43008
    v_mfma_f32_32x32x16_bf16 v[80:95], v[36:39], v[20:23], v[80:95]
    ds_read_b64_tr_b16 v[62:63], v7 offset:43520
    s_waitcnt lgkmcnt(0)
    v_mfma_f32_32x32x16_bf16 v[64:79], v[48:51], v[40:43], v[64:79]
    v_mfma_f32_32x32x16_bf16 v[80:95], v[56:59], v[40:43], v[80:95]
    v_mfma_f32_32x32x16_bf16 v[64:79], v[52:55], v[44:47], v[64:79]
    v_mfma_f32_32x32x16_bf16 v[80:95], v[60:63], v[44:47], v[80:95]
    s_and_b32 s50, s3, 1
    s_lshl_b32 s51, s59, 1
    s_add_u32 s50, s50, s51
    s_bfe_u32 s51, s3, 0x10001
    s_lshl_b32 s52, s60, 1
    s_add_u32 s51, s51, s52
    v_and_b32 v8, 63, v0
    v_lshlrev_b32 v9, 4, v8
    s_lshl_b32 s52, s51, 18
    s_lshl_b32 s53, s50, 11
    s_add_u32 s52, s52, s53
    s_lshr_b32 s53, s52, 1
    s_add_u32 s53, s53, 0x400000
    s_add_u32 s61, s52, 0x20000
    s_add_u32 s62, s53, 0x10000
    s_mov_b32 s58, 0x3eb8aa3b
    s_nop 7
    v_cvt_pk_bf16_f32 v16, v80, v81
    v_cvt_pk_bf16_f32 v17, v82, v83
    v_cvt_pk_bf16_f32 v18, v84, v85
    v_cvt_pk_bf16_f32 v19, v86, v87
    v_cvt_pk_bf16_f32 v20, v88, v89
    v_cvt_pk_bf16_f32 v21, v90, v91
    v_cvt_pk_bf16_f32 v22, v92, v93
    v_cvt_pk_bf16_f32 v23, v94, v95
    buffer_store_dwordx4 v[16:19], v9, s[24:27], s52 offen sc0 sc1
    buffer_store_dwordx4 v[20:23], v9, s[24:27], s61 offen sc0 sc1
    v_mul_f32 v64, s58, v64
    v_mul_f32 v65, s58, v65
    v_mul_f32 v66, s58, v66
    v_mul_f32 v67, s58, v67
    v_mul_f32 v68, s58, v68
    v_mul_f32 v69, s58, v69
    v_mul_f32 v70, s58, v70
    v_mul_f32 v71, s58, v71
    v_mul_f32 v72, s58, v72
    v_mul_f32 v73, s58, v73
    v_mul_f32 v74, s58, v74
    v_mul_f32 v75, s58, v75
    v_mul_f32 v76, s58, v76
    v_mul_f32 v77, s58, v77
    v_mul_f32 v78, s58, v78
    v_mul_f32 v79, s58, v79
    v_cvt_pk_bf16_f32 v24, v64, v65
    v_cvt_pk_bf16_f32 v25, v66, v67
    v_cvt_pk_bf16_f32 v26, v68, v69
    v_cvt_pk_bf16_f32 v27, v70, v71
    v_cvt_pk_bf16_f32 v28, v72, v73
    v_cvt_pk_bf16_f32 v29, v74, v75
    v_cvt_pk_bf16_f32 v30, v76, v77
    v_cvt_pk_bf16_f32 v31, v78, v79
    buffer_store_dwordx4 v[24:27], v9, s[24:27], s53 offen sc0 sc1
    buffer_store_dwordx4 v[28:31], v9, s[24:27], s62 offen sc0 sc1
    v_mul_f32 v32, v64, v64
    v_mul_f32 v33, v72, v72
    v_mul_f32 v34, v80, v80
    v_mul_f32 v35, v88, v88
    v_fmac_f32 v32, v65, v65
    v_fmac_f32 v33, v73, v73
    v_fmac_f32 v34, v81, v81
    v_fmac_f32 v35, v89, v89
    v_fmac_f32 v32, v66, v66
    v_fmac_f32 v33, v74, v74
    v_fmac_f32 v34, v82, v82
    v_fmac_f32 v35, v90, v90
    v_fmac_f32 v32, v67, v67
    v_fmac_f32 v33, v75, v75
    v_fmac_f32 v34, v83, v83
    v_fmac_f32 v35, v91, v91
    v_fmac_f32 v32, v68, v68
    v_fmac_f32 v33, v76, v76
    v_fmac_f32 v34, v84, v84
    v_fmac_f32 v35, v92, v92
    v_fmac_f32 v32, v69, v69
    v_fmac_f32 v33, v77, v77
    v_fmac_f32 v34, v85, v85
    v_fmac_f32 v35, v93, v93
    v_fmac_f32 v32, v70, v70
    v_fmac_f32 v33, v78, v78
    v_fmac_f32 v34, v86, v86
    v_fmac_f32 v35, v94, v94
    v_fmac_f32 v32, v71, v71
    v_fmac_f32 v33, v79, v79
    v_fmac_f32 v34, v87, v87
    v_fmac_f32 v35, v95, v95
    s_nop 1
    v_permlane32_swap_b32 v32, v33
    v_permlane32_swap_b32 v34, v35
    s_nop 1
    v_add_f32 v32, v32, v33
    v_add_f32 v33, v34, v35
    s_nop 1
    v_max_f32_dpp v32, v32, v32 row_shr:1 row_mask:0xf bank_mask:0xf
    v_max_f32_dpp v33, v33, v33 row_shr:1 row_mask:0xf bank_mask:0xf
    s_nop 1
    v_max_f32_dpp v32, v32, v32 row_shr:2 row_mask:0xf bank_mask:0xf
    v_max_f32_dpp v33, v33, v33 row_shr:2 row_mask:0xf bank_mask:0xf
    s_nop 1
    v_max_f32_dpp v32, v32, v32 row_shr:4 row_mask:0xf bank_mask:0xf
    v_max_f32_dpp v33, v33, v33 row_shr:4 row_mask:0xf bank_mask:0xf
    s_nop 1
    v_max_f32_dpp v32, v32, v32 row_shr:8 row_mask:0xf bank_mask:0xf
    v_max_f32_dpp v33, v33, v33 row_shr:8 row_mask:0xf bank_mask:0xf
    s_nop 1
    v_max_f32_dpp v32, v32, v32 row_bcast:15 row_mask:0xa bank_mask:0xf
    v_max_f32_dpp v33, v33, v33 row_bcast:15 row_mask:0xa bank_mask:0xf
    s_nop 1
    v_max_f32_dpp v32, v32, v32 row_bcast:31 row_mask:0xc bank_mask:0xf
    v_max_f32_dpp v33, v33, v33 row_bcast:31 row_mask:0xc bank_mask:0xf
    s_lshl_b32 s50, s60, 11
    s_lshl_b32 s51, s59, 6
    s_add_u32 s50, s50, s51
    s_lshl_b32 s51, s3, 3
    s_add_u32 s50, s50, s51
    s_add_u32 s50, s50, 0xf08010
    v_mov_b32 v10, 0
    s_brev_b64 exec, 1
    buffer_store_dwordx2 v[32:33], v10, s[24:27], s50 offen sc0 sc1
    s_mov_b64 exec, -1
    s_branch A_att
A_vwave:
    v_and_b32 v8, 31, v0
    v_and_b32 v9, 0x13, v8
    v_lshlrev_b32 v10, 1, v8
    v_and_b32 v10, 8, v10
    v_or_b32 v9, v9, v10
    v_lshrrev_b32 v10, 1, v8
    v_and_b32 v10, 4, v10
    v_or_b32 v8, v9, v10
    v_lshrrev_b32 v9, 1, v8
    v_and_b32 v9, 7, v9
    v_bfe_u32 v10, v0, 5, 1
    v_xor_b32 v9, v9, v10
    v_lshlrev_b32 v9, 4, v9
    v_lshl_add_u32 v9, v8, 7, v9
    v_bfe_u32 v8, v0, 6, 1
    v_lshl_add_u32 v3, v8, 12, v9
    v_xor_b32 v4, 32, v3
    v_xor_b32 v5, 64, v3
    v_xor_b32 v6, 96, v3
    v_bfe_u32 v8, v0, 2, 2
    v_lshl_add_u32 v9, v10, 3, v8
    v_lshlrev_b32 v9, 7, v9
    v_bfe_u32 v10, v0, 7, 1
    v_lshrrev_b32 v8, 1, v8
    v_xor_b32 v8, v8, v10
    v_lshl_add_u32 v9, v8, 6, v9
    v_bfe_u32 v8, v0, 4, 1
    v_lshl_add_u32 v9, v8, 5, v9
    v_and_b32 v8, 3, v0
    v_lshl_add_u32 v9, v8, 3, v9
    v_add_u32 v7, 24576, v9
    s_waitcnt vmcnt(8) lgkmcnt(0)
    s_barrier
    ds_read_b128 v[16:19], v3 offset:0
    ds_read_b64_tr_b16 v[24:25], v7 offset:8192
    ds_read_b64_tr_b16 v[26:27], v7 offset:8704
    ds_read_b128 v[20:23], v4 offset:0
    ds_read_b64_tr_b16 v[28:29], v7 offset:10240
    ds_read_b64_tr_b16 v[30:31], v7 offset:10752
    s_waitcnt vmcnt(6) lgkmcnt(0)
    s_barrier
    v_mfma_f32_32x32x16_bf16 v[64:79], v[16:19], v[24:27], 0
    ds_read_b128 v[40:43], v5 offset:0
    ds_read_b64_tr_b16 v[48:49], v7 offset:20480
    ds_read_b64_tr_b16 v[50:51], v7 offset:20992
    v_mfma_f32_32x32x16_bf16 v[64:79], v[20:23], v[28:31], v[64:79]
    ds_read_b128 v[44:47], v6 offset:0
    ds_read_b64_tr_b16 v[52:53], v7 offset:22528
    ds_read_b64_tr_b16 v[54:55], v7 offset:23040
    s_add_u32 m0, s49, 24576
    s_add_u32 s50, s57, s56
    buffer_load_dwordx4 v2, s[16:19], s50 offen lds
    s_add_u32 m0, s49, 27648
    s_nop 0
    buffer_load_dwordx4 v2, s[16:19], s50 offen offset:1024 lds
    s_add_u32 s56, s56, 98304
    s_cmp_eq_u32 s56, 1572864
    s_cselect_b32 s56, 0, s56
    s_waitcnt vmcnt(5) lgkmcnt(0)
    s_barrier
    v_mfma_f32_32x32x16_bf16 v[64:79], v[40:43], v[48:51], v[64:79]
    ds_read_b128 v[16:19], v3 offset:8192
    ds_read_b64_tr_b16 v[24:25], v7 offset:32768
    ds_read_b64_tr_b16 v[26:27], v7 offset:33280
    v_mfma_f32_32x32x16_bf16 v[64:79], v[44:47], v[52:55], v[64:79]
    ds_read_b128 v[20:23], v4 offset:8192
    ds_read_b64_tr_b16 v[28:29], v7 offset:34816
    ds_read_b64_tr_b16 v[30:31], v7 offset:35328
    s_add_u32 m0, s49, 36864
    s_add_u32 s50, s57, s56
    buffer_load_dwordx4 v2, s[16:19], s50 offen lds
    s_add_u32 m0, s49, 39936
    s_nop 0
    buffer_load_dwordx4 v2, s[16:19], s50 offen offset:1024 lds
    s_add_u32 s56, s56, 98304
    s_cmp_eq_u32 s56, 1572864
    s_cselect_b32 s56, 0, s56
    s_add_u32 m0, s49, 0
    s_add_u32 s50, s55, s54
    buffer_load_dwordx4 v1, s[12:15], s50 offen lds
    s_add_u32 s54, s54, 128
    s_and_b32 s54, s54, 1023
    s_waitcnt vmcnt(6) lgkmcnt(0)
    s_barrier
    v_mfma_f32_32x32x16_bf16 v[64:79], v[16:19], v[24:27], v[64:79]
    ds_read_b128 v[40:43], v5 offset:8192
    ds_read_b64_tr_b16 v[48:49], v7 offset:45056
    ds_read_b64_tr_b16 v[50:51], v7 offset:45568
    v_mfma_f32_32x32x16_bf16 v[64:79], v[20:23], v[28:31], v[64:79]
    ds_read_b128 v[44:47], v6 offset:8192
    ds_read_b64_tr_b16 v[52:53], v7 offset:47104
    ds_read_b64_tr_b16 v[54:55], v7 offset:47616
    s_add_u32 m0, s49, 49152
    s_add_u32 s50, s57, s56
    buffer_load_dwordx4 v2, s[16:19], s50 offen lds
    s_add_u32 m0, s49, 52224
    s_nop 0
    buffer_load_dwordx4 v2, s[16:19], s50 offen offset:1024 lds
    s_add_u32 s56, s56, 98304
    s_cmp_eq_u32 s56, 1572864
    s_cselect_b32 s56, 0, s56
    s_waitcnt vmcnt(5) lgkmcnt(0)
    s_barrier
    v_mfma_f32_32x32x16_bf16 v[64:79], v[40:43], v[48:51], v[64:79]
    ds_read_b128 v[16:19], v3 offset:16384
    ds_read_b64_tr_b16 v[24:25], v7 offset:8192
    ds_read_b64_tr_b16 v[26:27], v7 offset:8704
    v_mfma_f32_32x32x16_bf16 v[64:79], v[44:47], v[52:55], v[64:79]
    ds_read_b128 v[20:23], v4 offset:16384
    ds_read_b64_tr_b16 v[28:29], v7 offset:10240
    ds_read_b64_tr_b16 v[30:31], v7 offset:10752
    s_add_u32 m0, s49, 61440
    s_add_u32 s50, s57, s56
    buffer_load_dwordx4 v2, s[16:19], s50 offen lds
    s_add_u32 m0, s49, 64512
    s_nop 0
    buffer_load_dwordx4 v2, s[16:19], s50 offen offset:1024 lds
    s_add_u32 s56, s56, 98304
    s_cmp_eq_u32 s56, 1572864
    s_cselect_b32 s56, 0, s56
    s_add_u32 m0, s49, 8192
    s_add_u32 s50, s55, s54
    buffer_load_dwordx4 v1, s[12:15], s50 offen lds
    s_add_u32 s54, s54, 128
    s_and_b32 s54, s54, 1023
    s_waitcnt vmcnt(6) lgkmcnt(0)
    s_barrier
    v_mfma_f32_32x32x16_bf16 v[64:79], v[16:19], v[24:27], v[64:79]
    ds_read_b128 v[40:43], v5 offset:16384
    ds_read_b64_tr_b16 v[48:49], v7 offset:20480
    ds_read_b64_tr_b16 v[50:51], v7 offset:20992
    v_mfma_f32_32x32x16_bf16 v[64:79], v[20:23], v[28:31], v[64:79]
    ds_read_b128 v[44:47], v6 offset:16384
    ds_read_b64_tr_b16 v[52:53], v7 offset:22528
    ds_read_b64_tr_b16 v[54:55], v7 offset:23040
    s_add_u32 m0, s49, 24576
    s_add_u32 s50, s57, s56
    buffer_load_dwordx4 v2, s[16:19], s50 offen lds
    s_add_u32 m0, s49, 27648
    s_nop 0
    buffer_load_dwordx4 v2, s[16:19], s50 offen offset:1024 lds
    s_add_u32 s56, s56, 98304
    s_cmp_eq_u32 s56, 1572864
    s_cselect_b32 s56, 0, s56
    s_waitcnt vmcnt(5) lgkmcnt(0)
    s_barrier
    v_mfma_f32_32x32x16_bf16 v[64:79], v[40:43], v[48:51], v[64:79]
    ds_read_b128 v[16:19], v3 offset:0
    ds_read_b64_tr_b16 v[24:25], v7 offset:32768
    ds_read_b64_tr_b16 v[26:27], v7 offset:33280
    v_mfma_f32_32x32x16_bf16 v[64:79], v[44:47], v[52:55], v[64:79]
    ds_read_b128 v[20:23], v4 offset:0
    ds_read_b64_tr_b16 v[28:29], v7 offset:34816
    ds_read_b64_tr_b16 v[30:31], v7 offset:35328
    s_add_u32 m0, s49, 36864
    s_add_u32 s50, s57, s56
    buffer_load_dwordx4 v2, s[16:19], s50 offen lds
    s_add_u32 m0, s49, 39936
    s_nop 0
    buffer_load_dwordx4 v2, s[16:19], s50 offen offset:1024 lds
    s_add_u32 s56, s56, 98304
    s_cmp_eq_u32 s56, 1572864
    s_cselect_b32 s56, 0, s56
    s_add_u32 m0, s49, 16384
    s_add_u32 s50, s55, s54
    buffer_load_dwordx4 v1, s[12:15], s50 offen lds
    s_add_u32 s54, s54, 128
    s_and_b32 s54, s54, 1023
    s_waitcnt vmcnt(6) lgkmcnt(0)
    s_barrier
    v_mfma_f32_32x32x16_bf16 v[64:79], v[16:19], v[24:27], v[64:79]
    ds_read_b128 v[40:43], v5 offset:0
    ds_read_b64_tr_b16 v[48:49], v7 offset:45056
    ds_read_b64_tr_b16 v[50:51], v7 offset:45568
    v_mfma_f32_32x32x16_bf16 v[64:79], v[20:23], v[28:31], v[64:79]
    ds_read_b128 v[44:47], v6 offset:0
    ds_read_b64_tr_b16 v[52:53], v7 offset:47104
    ds_read_b64_tr_b16 v[54:55], v7 offset:47616
    s_add_u32 m0, s49, 49152
    s_add_u32 s50, s57, s56
    buffer_load_dwordx4 v2, s[16:19], s50 offen lds
    s_add_u32 m0, s49, 52224
    s_nop 0
    buffer_load_dwordx4 v2, s[16:19], s50 offen offset:1024 lds
    s_add_u32 s56, s56, 98304
    s_cmp_eq_u32 s56, 1572864
    s_cselect_b32 s56, 0, s56
    s_waitcnt vmcnt(5) lgkmcnt(0)
    s_barrier
    v_mfma_f32_32x32x16_bf16 v[64:79], v[40:43], v[48:51], v[64:79]
    ds_read_b128 v[16:19], v3 offset:8192
    ds_read_b64_tr_b16 v[24:25], v7 offset:8192
    ds_read_b64_tr_b16 v[26:27], v7 offset:8704
    v_mfma_f32_32x32x16_bf16 v[64:79], v[44:47], v[52:55], v[64:79]
    ds_read_b128 v[20:23], v4 offset:8192
    ds_read_b64_tr_b16 v[28:29], v7 offset:10240
    ds_read_b64_tr_b16 v[30:31], v7 offset:10752
    s_add_u32 m0, s49, 61440
    s_add_u32 s50, s57, s56
    buffer_load_dwordx4 v2, s[16:19], s50 offen lds
    s_add_u32 m0, s49, 64512
    s_nop 0
    buffer_load_dwordx4 v2, s[16:19], s50 offen offset:1024 lds
    s_add_u32 s56, s56, 98304
    s_cmp_eq_u32 s56, 1572864
    s_cselect_b32 s56, 0, s56
    s_add_u32 m0, s49, 0
    s_add_u32 s50, s55, s54
    buffer_load_dwordx4 v1, s[12:15], s50 offen lds
    s_add_u32 s54, s54, 128
    s_and_b32 s54, s54, 1023
    s_waitcnt vmcnt(6) lgkmcnt(0)
    s_barrier
    v_mfma_f32_32x32x16_bf16 v[64:79], v[16:19], v[24:27], v[64:79]
    ds_read_b128 v[40:43], v5 offset:8192
    ds_read_b64_tr_b16 v[48:49], v7 offset:20480
    ds_read_b64_tr_b16 v[50:51], v7 offset:20992
    v_mfma_f32_32x32x16_bf16 v[64:79], v[20:23], v[28:31], v[64:79]
    ds_read_b128 v[44:47], v6 offset:8192
    ds_read_b64_tr_b16 v[52:53], v7 offset:22528
    ds_read_b64_tr_b16 v[54:55], v7 offset:23040
    s_add_u32 m0, s49, 24576
    s_add_u32 s50, s57, s56
    buffer_load_dwordx4 v2, s[16:19], s50 offen lds
    s_add_u32 m0, s49, 27648
    s_nop 0
    buffer_load_dwordx4 v2, s[16:19], s50 offen offset:1024 lds
    s_add_u32 s56, s56, 98304
    s_cmp_eq_u32 s56, 1572864
    s_cselect_b32 s56, 0, s56
    s_waitcnt vmcnt(5) lgkmcnt(0)
    s_barrier
    v_mfma_f32_32x32x16_bf16 v[64:79], v[40:43], v[48:51], v[64:79]
    ds_read_b128 v[16:19], v3 offset:16384
    ds_read_b64_tr_b16 v[24:25], v7 offset:32768
    ds_read_b64_tr_b16 v[26:27], v7 offset:33280
    v_mfma_f32_32x32x16_bf16 v[64:79], v[44:47], v[52:55], v[64:79]
    ds_read_b128 v[20:23], v4 offset:16384
    ds_read_b64_tr_b16 v[28:29], v7 offset:34816
    ds_read_b64_tr_b16 v[30:31], v7 offset:35328
    s_add_u32 m0, s49, 36864
    s_add_u32 s50, s57, s56
    buffer_load_dwordx4 v2, s[16:19], s50 offen lds
    s_add_u32 m0, s49, 39936
    s_nop 0
    buffer_load_dwordx4 v2, s[16:19], s50 offen offset:1024 lds
    s_add_u32 s56, s56, 98304
    s_cmp_eq_u32 s56, 1572864
    s_cselect_b32 s56, 0, s56
    s_add_u32 m0, s49, 8192
    s_add_u32 s50, s55, s54
    buffer_load_dwordx4 v1, s[12:15], s50 offen lds
    s_add_u32 s54, s54, 128
    s_and_b32 s54, s54, 1023
    s_waitcnt vmcnt(6) lgkmcnt(0)
    s_barrier
    v_mfma_f32_32x32x16_bf16 v[64:79], v[16:19], v[24:27], v[64:79]
    ds_read_b128 v[40:43], v5 offset:16384
    ds_read_b64_tr_b16 v[48:49], v7 offset:45056
    ds_read_b64_tr_b16 v[50:51], v7 offset:45568
    v_mfma_f32_32x32x16_bf16 v[64:79], v[20:23], v[28:31], v[64:79]
    ds_read_b128 v[44:47], v6 offset:16384
    ds_read_b64_tr_b16 v[52:53], v7 offset:47104
    ds_read_b64_tr_b16 v[54:55], v7 offset:47616
    s_add_u32 m0, s49, 49152
    s_add_u32 s50, s57, s56
    buffer_load_dwordx4 v2, s[16:19], s50 offen lds
    s_add_u32 m0, s49, 52224
    s_nop 0
    buffer_load_dwordx4 v2, s[16:19], s50 offen offset:1024 lds
    s_add_u32 s56, s56, 98304
    s_cmp_eq_u32 s56, 1572864
    s_cselect_b32 s56, 0, s56
    s_waitcnt vmcnt(5) lgkmcnt(0)
    s_barrier
    v_mfma_f32_32x32x16_bf16 v[64:79], v[40:43], v[48:51], v[64:79]
    ds_read_b128 v[16:19], v3 offset:0
    ds_read_b64_tr_b16 v[24:25], v7 offset:8192
    ds_read_b64_tr_b16 v[26:27], v7 offset:8704
    v_mfma_f32_32x32x16_bf16 v[64:79], v[44:47], v[52:55], v[64:79]
    ds_read_b128 v[20:23], v4 offset:0
    ds_read_b64_tr_b16 v[28:29], v7 offset:10240
    ds_read_b64_tr_b16 v[30:31], v7 offset:10752
    s_add_u32 m0, s49, 61440
    s_add_u32 s50, s57, s56
    buffer_load_dwordx4 v2, s[16:19], s50 offen lds
    s_add_u32 m0, s49, 64512
    s_nop 0
    buffer_load_dwordx4 v2, s[16:19], s50 offen offset:1024 lds
    s_add_u32 s56, s56, 98304
    s_cmp_eq_u32 s56, 1572864
    s_cselect_b32 s56, 0, s56
    s_waitcnt vmcnt(5) lgkmcnt(0)
    s_barrier
    v_mfma_f32_32x32x16_bf16 v[64:79], v[16:19], v[24:27], v[64:79]
    ds_read_b128 v[40:43], v5 offset:0
    ds_read_b64_tr_b16 v[48:49], v7 offset:20480
    ds_read_b64_tr_b16 v[50:51], v7 offset:20992
    v_mfma_f32_32x32x16_bf16 v[64:79], v[20:23], v[28:31], v[64:79]
    ds_read_b128 v[44:47], v6 offset:0
    ds_read_b64_tr_b16 v[52:53], v7 offset:22528
    ds_read_b64_tr_b16 v[54:55], v7 offset:23040
    s_waitcnt vmcnt(2) lgkmcnt(0)
    s_barrier
    v_mfma_f32_32x32x16_bf16 v[64:79], v[40:43], v[48:51], v[64:79]
    ds_read_b128 v[16:19], v3 offset:8192
    ds_read_b64_tr_b16 v[24:25], v7 offset:32768
    ds_read_b64_tr_b16 v[26:27], v7 offset:33280
    v_mfma_f32_32x32x16_bf16 v[64:79], v[44:47], v[52:55], v[64:79]
    ds_read_b128 v[20:23], v4 offset:8192
    ds_read_b64_tr_b16 v[28:29], v7 offset:34816
    ds_read_b64_tr_b16 v[30:31], v7 offset:35328
    s_waitcnt vmcnt(0) lgkmcnt(0)
    s_barrier
    v_mfma_f32_32x32x16_bf16 v[64:79], v[16:19], v[24:27], v[64:79]
    ds_read_b128 v[40:43], v5 offset:8192
    ds_read_b64_tr_b16 v[48:49], v7 offset:45056
    ds_read_b64_tr_b16 v[50:51], v7 offset:45568
    v_mfma_f32_32x32x16_bf16 v[64:79], v[20:23], v[28:31], v[64:79]
    ds_read_b128 v[44:47], v6 offset:8192
    ds_read_b64_tr_b16 v[52:53], v7 offset:47104
    ds_read_b64_tr_b16 v[54:55], v7 offset:47616
    s_waitcnt lgkmcnt(0)
    v_mfma_f32_32x32x16_bf16 v[64:79], v[40:43], v[48:51], v[64:79]
    v_mfma_f32_32x32x16_bf16 v[64:79], v[44:47], v[52:55], v[64:79]
    s_and_b32 s50, s3, 1
    s_lshl_b32 s51, s59, 1
    s_add_u32 s50, s50, s51
    s_bfe_u32 s51, s3, 0x10001
    s_lshl_b32 s52, s60, 1
    s_add_u32 s51, s51, s52
    v_and_b32 v8, 63, v0
    v_and_b32 v9, 15, v8
    v_lshlrev_b32 v9, 4, v9
    v_bfe_u32 v10, v8, 5, 1
    v_lshl_add_u32 v9, v10, 8, v9
    v_bfe_u32 v10, v8, 4, 1
    v_lshl_add_u32 v9, v10, 17, v9
    s_lshl_b32 s51, s51, 18
    s_lshl_b32 s50, s50, 11
    s_add_u32 s50, s50, s51
    s_nop 7
    v_cvt_pk_bf16_f32 v16, v64, v65
    v_cvt_pk_bf16_f32 v17, v66, v67
    v_cvt_pk_bf16_f32 v18, v68, v69
    v_cvt_pk_bf16_f32 v19, v70, v71
    v_cvt_pk_bf16_f32 v20, v72, v73
    v_cvt_pk_bf16_f32 v21, v74, v75
    v_cvt_pk_bf16_f32 v22, v76, v77
    v_cvt_pk_bf16_f32 v23, v78, v79
    buffer_store_dwordx4 v[16:19], v9, s[24:27], s50 offen offset:1024 sc0 sc1
    buffer_store_dwordx4 v[20:23], v9, s[24:27], s50 offen offset:1536 sc0 sc1
A_att:
    s_bfe_u32 s61, s2, 0x20001
    s_andn2_b32 s50, 1, s2
    s_lshl_b32 s50, s50, 2
    s_add_u32 s61, s61, s50
    s_lshr_b32 s50, s2, 6
    s_lshl_b32 s62, s61, 2
    s_add_u32 s62, s62, s50
    s_lshl_b32 s50, s60, 11
    s_lshl_b32 s51, s59, 6
    s_add_u32 s50, s50, s51
    s_add_u32 s55, s50, 0xf08000
    s_bfe_u32 s59, s2, 0x30003
    v_and_b32 v8, 63, v0
    v_lshlrev_b32 v119, 4, v8
    s_lshl_b32 s49, s3, 11
    v_add_u32 v115, s49, v119
    s_lshl_b32 s57, s62, 17
    s_mov_b32 s56, 0
    s_mov_b32 s54, 0
    s_lshl_b32 s51, s59, 3
    s_and_b32 s52, s3, 3
    s_lshl_b32 s52, s52, 1
    s_add_u32 s60, s51, s52
    s_lshl_b32 s51, s60, 10
    s_lshl_b32 s52, s62, 16
    s_add_u32 s51, s51, s52
    s_add_u32 s4, s51, 0x400000
    s_lshr_b32 s53, s3, 2
    s_add_u32 s53, s60, s53
    s_mul_i32 s5, s53, 144
    s_add_u32 s5, s5, s62
    s_lshl_b32 s5, s5, 10
    s_add_u32 s5, s5, 0x61c000
    s_lshl_b32 s6, s53, 11
    s_lshl_b32 s52, s62, 6
    s_add_u32 s6, s6, s52
    s_add_u32 s6, s6, 0xf20000
    s_add_u32 s7, s6, 0x20000
    s_lshr_b32 s50, s3, 2
    s_lshl_b32 s50, s50, 11
    v_add_u32 v116, s50, v119
    v_and_b32 v9, 15, v8
    v_lshlrev_b32 v9, 4, v9
    v_bfe_u32 v10, v8, 5, 1
    v_lshl_add_u32 v9, v10, 8, v9
    s_add_u32 s50, s50, 1024
    v_add_u32 v117, s50, v9
    v_mov_b32 v113, v116
    v_mov_b32 v114, v117
    v_mov_b32 v112, 0xdddddddd
    v_and_b32 v9, 27, v8
    v_cmp_eq_u32 vcc, 16, v9
    v_mov_b32 v9, 0x3f803f80
    s_nop 0
    v_cndmask_b32 v96, 0, v9, vcc
    v_mov_b32 v97, v96
    v_mov_b32 v98, v96
    v_mov_b32 v99, v96
    v_mov_b32 v100, v96
    v_mov_b32 v101, v96
    v_mov_b32 v102, v96
    v_mov_b32 v103, v96
    v_mov_b32 v104, v96
    v_mov_b32 v105, v96
    v_mov_b32 v106, v96
    v_mov_b32 v107, v96
    v_mov_b32 v108, v96
    v_mov_b32 v109, v96
    v_mov_b32 v110, v96
    v_mov_b32 v111, v96
    s_mov_b32 s64, 0xffff
    s_mov_b32 s65, 0xffff
    s_mov_b32 s63, 0
    s_mov_b32 s58, 0
    v_mov_b32 v48, 0
    v_mov_b32 v49, 0
    v_mov_b32 v50, 0
    v_mov_b32 v51, 0
    v_mov_b32 v52, 0
    v_mov_b32 v53, 0
    v_mov_b32 v54, 0
    v_mov_b32 v55, 0
    v_mov_b32 v56, 0
    v_mov_b32 v57, 0
    v_mov_b32 v58, 0
    v_mov_b32 v59, 0
    v_mov_b32 v60, 0
    v_mov_b32 v61, 0
    v_mov_b32 v62, 0
    v_mov_b32 v63, 0
    v_mov_b32 v64, 0
    v_mov_b32 v65, 0
    v_mov_b32 v66, 0
    v_mov_b32 v67, 0
    v_mov_b32 v68, 0
    v_mov_b32 v69, 0
    v_mov_b32 v70, 0
    v_mov_b32 v71, 0
    v_mov_b32 v72, 0
    v_mov_b32 v73, 0
    v_mov_b32 v74, 0
    v_mov_b32 v75, 0
    v_mov_b32 v76, 0
    v_mov_b32 v77, 0
    v_mov_b32 v78, 0
    v_mov_b32 v79, 0
    v_mov_b32 v40, 0
    v_mov_b32 v41, 0
    v_mov_b32 v42, 0
    v_mov_b32 v43, 0
    v_mov_b32 v44, 0
    v_mov_b32 v45, 0
    v_mov_b32 v46, 0
    v_mov_b32 v47, 0
    s_waitcnt vmcnt(0)
    s_barrier
    s_cmp_lg_u32 s3, 0
    s_cbranch_scc1 A_wait1
    v_readfirstlane_b32 s48, v14
    s_nop 3
    s_cmp_lg_u32 s48, 0
    s_cbranch_scc1 A_tag_ok
    s_mov_b32 s66, 0x40000
    v_mov_b32 v10, 0
A_tag:
    buffer_load_dword v11, v10, s[28:31], 0 offen sc1
    s_waitcnt vmcnt(0)
    v_readfirstlane_b32 s48, v11
    s_nop 3
    s_cmp_lg_u32 s48, 0
    s_cbranch_scc1 A_tag_ok
    s_sleep 4
    s_sub_u32 s66, s66, 1
    s_cmp_lg_u32 s66, 0
    s_cbranch_scc1 A_tag
A_tag_ok:
    s_mov_b64 exec, 1
    v_mov_b32 v10, 0
    v_mov_b32 v11, s48
    buffer_store_dword v11, v10, s[24:27], s55 offen sc0 sc1
    s_mov_b64 exec, -1
    v_and_b32 v10, 31, v0
    v_lshlrev_b32 v10, 6, v10
    s_bfe_u32 s51, s62, 0x10001
    s_lshl_b32 s51, s51, 4
    s_add_u32 s51, s51, 16
    v_bfe_u32 v11, v0, 5, 1
    v_mul_u32_u24 v11, s51, v11
    v_add_u32 v10, v10, v11
    s_lshl_b32 s50, s61, 11
    s_add_u32 s50, s50, 0xf08000
    s_mov_b32 s66, 0x40000
A_pollkv:
    buffer_load_dwordx4 v[4:7], v10, s[24:27], s50 offen sc1
    s_waitcnt vmcnt(0)
    v_cmp_ne_u32 vcc, s48, v4
    s_nop 4
    s_cmp_eq_u32 vcc_lo, 0
    s_cbranch_scc1 A_pollkv_ok
    s_sleep 0
    s_sub_u32 s66, s66, 1
    s_cmp_lg_u32 s66, 0
    s_cbranch_scc1 A_pollkv
A_pollkv_ok:
    s_barrier
    s_branch A_go
A_wait1:
    s_barrier
A_go:
    s_add_u32 m0, s54, s49
    s_add_u32 s50, s57, s56
    buffer_load_dwordx4 v115, s[24:27], s50 offen sc1 lds
    buffer_load_dwordx4 v115, s[24:27], s50 offen offset:1024 sc1 lds
    s_add_u32 s56, s56, 16384
    s_and_b32 s56, s56, 0x1ffff
    s_add_u32 s54, s54, 16384
    s_cmp_eq_u32 s54, 81920
    s_cselect_b32 s54, 0, s54
    buffer_load_dwordx4 v[80:83], v119, s[24:27], s4 offen sc1
    buffer_load_dwordx4 v[84:87], v119, s[24:27], s4 offen offset:1024 sc1
    s_add_u32 m0, s54, s49
    s_add_u32 s50, s57, s56
    buffer_load_dwordx4 v115, s[24:27], s50 offen sc1 lds
    buffer_load_dwordx4 v115, s[24:27], s50 offen offset:1024 sc1 lds
    s_add_u32 s56, s56, 16384
    s_and_b32 s56, s56, 0x1ffff
    s_add_u32 s54, s54, 16384
    s_cmp_eq_u32 s54, 81920
    s_cselect_b32 s54, 0, s54
    s_cmp_lg_u32 s3, 0
    s_cbranch_scc1 A_nored
    v_max_u32 v4, v4, v6
    v_max_u32 v5, v5, v7
    s_nop 1
    v_max_u32_dpp v4, v4, v4 row_shr:1 row_mask:0xf bank_mask:0xf
    v_max_u32_dpp v5, v5, v5 row_shr:1 row_mask:0xf bank_mask:0xf
    s_nop 1
    v_max_u32_dpp v4, v4, v4 row_shr:2 row_mask:0xf bank_mask:0xf
    v_max_u32_dpp v5, v5, v5 row_shr:2 row_mask:0xf bank_mask:0xf
    s_nop 1
    v_max_u32_dpp v4, v4, v4 row_shr:4 row_mask:0xf bank_mask:0xf
    v_max_u32_dpp v5, v5, v5 row_shr:4 row_mask:0xf bank_mask:0xf
    s_nop 1
    v_max_u32_dpp v4, v4, v4 row_shr:8 row_mask:0xf bank_mask:0xf
    v_max_u32_dpp v5, v5, v5 row_shr:8 row_mask:0xf bank_mask:0xf
    s_nop 1
    v_max_u32_dpp v4, v4, v4 row_bcast:15 row_mask:0xa bank_mask:0xf
    v_max_u32_dpp v5, v5, v5 row_bcast:15 row_mask:0xa bank_mask:0xf
    s_nop 0
    v_mul_f32 v4, v4, v5
    v_mov_b32 v5, s48
    v_mov_b32 v6, 81912
    s_brev_b64 exec, 1
    ds_write_b64 v6, v[4:5]
    s_mov_b64 exec, -1
    s_waitcnt lgkmcnt(0)
A_nored:
    s_setprio 0
    s_waitcnt vmcnt(2)
    s_barrier
    ds_read_b128 v[88:91], v113
    s_mov_b64 exec, s[64:65]
    ds_read_b128 v[96:99], v114 offset:0
    ds_read_b128 v[100:103], v114 offset:512
    s_mov_b64 exec, -1
    v_mov_b32 v6, 81912
    ds_read_b64 v[4:5], v6
    s_waitcnt lgkmcnt(0)
    v_readfirstlane_b32 s50, v4
    v_readfirstlane_b32 s48, v5
    v_mfma_f32_32x32x16_bf16 v[16:31], v[88:91], v[80:83], 0
    s_nop 3
    s_cmp_gt_u32 s50, 0x45548000
    s_cbranch_scc1 A_slow
    s_nop 7
.p2align 6
A_loop:
    v_exp_f32 v16, v16
    v_exp_f32 v17, v17
    v_exp_f32 v18, v18
    v_smfmac_f32_32x32x32_bf16 v[64:79], v[108:111], v[40:47], v112
    ds_read_b128 v[92:95], v113 offset:4096
    s_mov_b64 exec, s[64:65]
    ds_read_b128 v[104:107], v114 offset:4096
    ds_read_b128 v[108:111], v114 offset:4608
    s_mov_b64 exec, -1
    v_exp_f32 v19, v19
    v_exp_f32 v20, v20
    v_exp_f32 v21, v21
    v_exp_f32 v22, v22
    v_exp_f32 v23, v23
    v_mfma_f32_32x32x16_bf16 v[32:47], v[88:91], v[84:87], 0
    v_exp_f32 v24, v24
    v_exp_f32 v25, v25
    v_exp_f32 v26, v26
    v_exp_f32 v27, v27
    v_exp_f32 v28, v28
    v_smfmac_f32_32x32x32_bf16 v[48:63], v[96:99], v[16:23], v112
    v_exp_f32 v29, v29
    v_exp_f32 v30, v30
    v_exp_f32 v31, v31
    v_exp_f32 v32, v32
    v_exp_f32 v33, v33
    v_exp_f32 v34, v34
    v_smfmac_f32_32x32x32_bf16 v[48:63], v[100:103], v[24:31], v112
    v_exp_f32 v35, v35
    v_exp_f32 v36, v36
    v_exp_f32 v37, v37
    v_exp_f32 v38, v38
    v_exp_f32 v39, v39
    s_waitcnt lgkmcnt(0)
    v_mfma_f32_32x32x16_bf16 v[16:31], v[92:95], v[80:83], 0
    v_exp_f32 v40, v40
    v_exp_f32 v41, v41
    v_exp_f32 v42, v42
    v_exp_f32 v43, v43
    v_exp_f32 v44, v44
    v_smfmac_f32_32x32x32_bf16 v[64:79], v[96:99], v[32:39], v112
    s_cmp_lg_u32 s58, 2
    s_cbranch_scc1 A_rf1
    s_add_u32 m0, s54, s49
    s_add_u32 s50, s57, s56
    buffer_load_dwordx4 v115, s[24:27], s50 offen sc1 lds
    buffer_load_dwordx4 v115, s[24:27], s50 offen offset:1024 sc1 lds
    s_add_u32 s56, s56, 16384
    s_and_b32 s56, s56, 0x1ffff
    s_add_u32 s54, s54, 16384
    s_cmp_eq_u32 s54, 81920
    s_cselect_b32 s54, 0, s54
A_rf1:
    v_exp_f32 v45, v45
    v_exp_f32 v46, v46
    v_exp_f32 v47, v47
    v_exp_f32 v16, v16
    v_exp_f32 v17, v17
    v_exp_f32 v18, v18
    v_smfmac_f32_32x32x32_bf16 v[64:79], v[100:103], v[40:47], v112
    ds_read_b128 v[88:91], v113 offset:8192
    s_mov_b64 exec, s[64:65]
    ds_read_b128 v[96:99], v114 offset:8192
    ds_read_b128 v[100:103], v114 offset:8704
    s_mov_b64 exec, -1
    v_exp_f32 v19, v19
    v_exp_f32 v20, v20
    v_exp_f32 v21, v21
    v_exp_f32 v22, v22
    v_exp_f32 v23, v23
    v_mfma_f32_32x32x16_bf16 v[32:47], v[92:95], v[84:87], 0
    v_exp_f32 v24, v24
    v_exp_f32 v25, v25
    v_exp_f32 v26, v26
    v_exp_f32 v27, v27
    v_exp_f32 v28, v28
    v_smfmac_f32_32x32x32_bf16 v[48:63], v[104:107], v[16:23], v112
    v_exp_f32 v29, v29
    v_exp_f32 v30, v30
    v_exp_f32 v31, v31
    v_exp_f32 v32, v32
    v_exp_f32 v33, v33
    v_exp_f32 v34, v34
    v_smfmac_f32_32x32x32_bf16 v[48:63], v[108:111], v[24:31], v112
    v_exp_f32 v35, v35
    v_exp_f32 v36, v36
    v_exp_f32 v37, v37
    v_exp_f32 v38, v38
    v_exp_f32 v39, v39
    s_waitcnt lgkmcnt(0)
    v_mfma_f32_32x32x16_bf16 v[16:31], v[88:91], v[80:83], 0
    v_exp_f32 v40, v40
    v_exp_f32 v41, v41
    v_exp_f32 v42, v42
    v_exp_f32 v43, v43
    v_exp_f32 v44, v44
    v_smfmac_f32_32x32x32_bf16 v[64:79], v[104:107], v[32:39], v112
    s_cmp_lg_u32 s58, 0
    s_cbranch_scc1 A_rf3
    s_add_u32 m0, s54, s49
    s_add_u32 s50, s57, s56
    buffer_load_dwordx4 v115, s[24:27], s50 offen sc1 lds
    buffer_load_dwordx4 v115, s[24:27], s50 offen offset:1024 sc1 lds
    s_add_u32 s56, s56, 16384
    s_and_b32 s56, s56, 0x1ffff
    s_add_u32 s54, s54, 16384
    s_cmp_eq_u32 s54, 81920
    s_cselect_b32 s54, 0, s54
A_rf3:
    v_exp_f32 v45, v45
    v_exp_f32 v46, v46
    v_exp_f32 v47, v47
    s_setprio 1
    v_exp_f32 v16, v16
    v_exp_f32 v17, v17
    v_exp_f32 v18, v18
    v_smfmac_f32_32x32x32_bf16 v[64:79], v[108:111], v[40:47], v112
    ds_read_b128 v[92:95], v113 offset:12288
    s_mov_b64 exec, s[64:65]
    ds_read_b128 v[104:107], v114 offset:12288
    ds_read_b128 v[108:111], v114 offset:12800
    s_mov_b64 exec, -1
    v_exp_f32 v19, v19
    v_exp_f32 v20, v20
    v_exp_f32 v21, v21
    v_exp_f32 v22, v22
    v_exp_f32 v23, v23
    v_mfma_f32_32x32x16_bf16 v[32:47], v[88:91], v[84:87], 0
    v_exp_f32 v24, v24
    v_exp_f32 v25, v25
    v_exp_f32 v26, v26
    v_exp_f32 v27, v27
    v_exp_f32 v28, v28
    v_smfmac_f32_32x32x32_bf16 v[48:63], v[96:99], v[16:23], v112
    v_exp_f32 v29, v29
    v_exp_f32 v30, v30
    v_exp_f32 v31, v31
    v_exp_f32 v32, v32
    v_exp_f32 v33, v33
    v_exp_f32 v34, v34
    v_smfmac_f32_32x32x32_bf16 v[48:63], v[100:103], v[24:31], v112
    v_exp_f32 v35, v35
    v_exp_f32 v36, v36
    v_exp_f32 v37, v37
    v_exp_f32 v38, v38
    v_exp_f32 v39, v39
    s_waitcnt lgkmcnt(0)
    v_mfma_f32_32x32x16_bf16 v[16:31], v[92:95], v[80:83], 0
    v_exp_f32 v40, v40
    v_exp_f32 v41, v41
    v_exp_f32 v42, v42
    v_exp_f32 v43, v43
    v_exp_f32 v44, v44
    v_smfmac_f32_32x32x32_bf16 v[64:79], v[96:99], v[32:39], v112
    s_cmp_lg_u32 s58, 0
    s_cbranch_scc1 A_rf5
    s_add_u32 m0, s54, s49
    s_add_u32 s50, s57, s56
    buffer_load_dwordx4 v115, s[24:27], s50 offen sc1 lds
    buffer_load_dwordx4 v115, s[24:27], s50 offen offset:1024 sc1 lds
    s_add_u32 s56, s56, 16384
    s_and_b32 s56, s56, 0x1ffff
    s_add_u32 s54, s54, 16384
    s_cmp_eq_u32 s54, 81920
    s_cselect_b32 s54, 0, s54
A_rf5:
    v_exp_f32 v45, v45
    v_exp_f32 v46, v46
    v_exp_f32 v47, v47
    s_cmp_lg_u32 s58, 0
    s_cbranch_scc1 A_nb
    s_waitcnt vmcnt(4)
    s_barrier
A_nb:
    s_add_u32 s63, s63, 16384
    s_cmp_eq_u32 s63, 81920
    s_cselect_b32 s63, 0, s63
    v_add_u32 v113, s63, v116
    v_add_u32 v114, s63, v117
    v_exp_f32 v16, v16
    v_exp_f32 v17, v17
    v_exp_f32 v18, v18
    v_smfmac_f32_32x32x32_bf16 v[64:79], v[100:103], v[40:47], v112
    ds_read_b128 v[88:91], v113 offset:0
    s_mov_b64 exec, s[64:65]
    ds_read_b128 v[96:99], v114 offset:0
    ds_read_b128 v[100:103], v114 offset:512
    s_mov_b64 exec, -1
    v_exp_f32 v19, v19
    v_exp_f32 v20, v20
    v_exp_f32 v21, v21
    v_exp_f32 v22, v22
    v_exp_f32 v23, v23
    v_mfma_f32_32x32x16_bf16 v[32:47], v[92:95], v[84:87], 0
    v_exp_f32 v24, v24
    v_exp_f32 v25, v25
    v_exp_f32 v26, v26
    v_exp_f32 v27, v27
    v_exp_f32 v28, v28
    v_smfmac_f32_32x32x32_bf16 v[48:63], v[104:107], v[16:23], v112
    v_exp_f32 v29, v29
    v_exp_f32 v30, v30
    v_exp_f32 v31, v31
    v_exp_f32 v32, v32
    v_exp_f32 v33, v33
    v_exp_f32 v34, v34
    v_smfmac_f32_32x32x32_bf16 v[48:63], v[108:111], v[24:31], v112
    v_exp_f32 v35, v35
    v_exp_f32 v36, v36
    v_exp_f32 v37, v37
    v_exp_f32 v38, v38
    v_exp_f32 v39, v39
    s_waitcnt lgkmcnt(0)
    v_mfma_f32_32x32x16_bf16 v[16:31], v[88:91], v[80:83], 0
    v_exp_f32 v40, v40
    v_exp_f32 v41, v41
    v_exp_f32 v42, v42
    v_exp_f32 v43, v43
    v_exp_f32 v44, v44
    v_smfmac_f32_32x32x32_bf16 v[64:79], v[104:107], v[32:39], v112
    s_cmp_lg_u32 s58, 0
    s_cbranch_scc1 A_rf7
    s_add_u32 m0, s54, s49
    s_add_u32 s50, s57, s56
    buffer_load_dwordx4 v115, s[24:27], s50 offen sc1 lds
    buffer_load_dwordx4 v115, s[24:27], s50 offen offset:1024 sc1 lds
    s_add_u32 s56, s56, 16384
    s_and_b32 s56, s56, 0x1ffff
    s_add_u32 s54, s54, 16384
    s_cmp_eq_u32 s54, 81920
    s_cselect_b32 s54, 0, s54
A_rf7:
    v_exp_f32 v45, v45
    v_exp_f32 v46, v46
    v_exp_f32 v47, v47
    v_exp_f32 v16, v16
    v_exp_f32 v17, v17
    v_exp_f32 v18, v18
    v_smfmac_f32_32x32x32_bf16 v[64:79], v[108:111], v[40:47], v112
    ds_read_b128 v[92:95], v113 offset:4096
    s_mov_b64 exec, s[64:65]
    ds_read_b128 v[104:107], v114 offset:4096
    ds_read_b128 v[108:111], v114 offset:4608
    s_mov_b64 exec, -1
    v_exp_f32 v19, v19
    v_exp_f32 v20, v20
    v_exp_f32 v21, v21
    v_exp_f32 v22, v22
    v_exp_f32 v23, v23
    v_mfma_f32_32x32x16_bf16 v[32:47], v[88:91], v[84:87], 0
    v_exp_f32 v24, v24
    v_exp_f32 v25, v25
    v_exp_f32 v26, v26
    v_exp_f32 v27, v27
    v_exp_f32 v28, v28
    v_smfmac_f32_32x32x32_bf16 v[48:63], v[96:99], v[16:23], v112
    v_exp_f32 v29, v29
    v_exp_f32 v30, v30
    v_exp_f32 v31, v31
    v_exp_f32 v32, v32
    v_exp_f32 v33, v33
    v_exp_f32 v34, v34
    v_smfmac_f32_32x32x32_bf16 v[48:63], v[100:103], v[24:31], v112
    v_exp_f32 v35, v35
    v_exp_f32 v36, v36
    v_exp_f32 v37, v37
    v_exp_f32 v38, v38
    v_exp_f32 v39, v39
    s_waitcnt lgkmcnt(0)
    v_mfma_f32_32x32x16_bf16 v[16:31], v[92:95], v[80:83], 0
    v_exp_f32 v40, v40
    v_exp_f32 v41, v41
    v_exp_f32 v42, v42
    v_exp_f32 v43, v43
    v_exp_f32 v44, v44
    v_smfmac_f32_32x32x32_bf16 v[64:79], v[96:99], v[32:39], v112
    v_exp_f32 v45, v45
    v_exp_f32 v46, v46
    v_exp_f32 v47, v47
    s_setprio 0
    v_exp_f32 v16, v16
    v_exp_f32 v17, v17
    v_exp_f32 v18, v18
    v_smfmac_f32_32x32x32_bf16 v[64:79], v[100:103], v[40:47], v112
    ds_read_b128 v[88:91], v113 offset:8192
    s_mov_b64 exec, s[64:65]
    ds_read_b128 v[96:99], v114 offset:8192
    ds_read_b128 v[100:103], v114 offset:8704
    s_mov_b64 exec, -1
    v_exp_f32 v19, v19
    v_exp_f32 v20, v20
    v_exp_f32 v21, v21
    v_exp_f32 v22, v22
    v_exp_f32 v23, v23
    v_mfma_f32_32x32x16_bf16 v[32:47], v[92:95], v[84:87], 0
    v_exp_f32 v24, v24
    v_exp_f32 v25, v25
    v_exp_f32 v26, v26
    v_exp_f32 v27, v27
    v_exp_f32 v28, v28
    v_smfmac_f32_32x32x32_bf16 v[48:63], v[104:107], v[16:23], v112
    v_exp_f32 v29, v29
    v_exp_f32 v30, v30
    v_exp_f32 v31, v31
    v_exp_f32 v32, v32
    v_exp_f32 v33, v33
    v_exp_f32 v34, v34
    v_smfmac_f32_32x32x32_bf16 v[48:63], v[108:111], v[24:31], v112
    v_exp_f32 v35, v35
    v_exp_f32 v36, v36
    v_exp_f32 v37, v37
    v_exp_f32 v38, v38
    v_exp_f32 v39, v39
    s_waitcnt lgkmcnt(0)
    v_mfma_f32_32x32x16_bf16 v[16:31], v[88:91], v[80:83], 0
    v_exp_f32 v40, v40
    v_exp_f32 v41, v41
    v_exp_f32 v42, v42
    v_exp_f32 v43, v43
    v_exp_f32 v44, v44
    v_smfmac_f32_32x32x32_bf16 v[64:79], v[104:107], v[32:39], v112
    v_exp_f32 v45, v45
    v_exp_f32 v46, v46
    v_exp_f32 v47, v47
    v_exp_f32 v16, v16
    v_exp_f32 v17, v17
    v_exp_f32 v18, v18
    v_smfmac_f32_32x32x32_bf16 v[64:79], v[108:111], v[40:47], v112
    ds_read_b128 v[92:95], v113 offset:12288
    s_mov_b64 exec, s[64:65]
    ds_read_b128 v[104:107], v114 offset:12288
    ds_read_b128 v[108:111], v114 offset:12800
    s_mov_b64 exec, -1
    v_exp_f32 v19, v19
    v_exp_f32 v20, v20
    v_exp_f32 v21, v21
    v_exp_f32 v22, v22
    v_exp_f32 v23, v23
    v_mfma_f32_32x32x16_bf16 v[32:47], v[88:91], v[84:87], 0
    v_exp_f32 v24, v24
    v_exp_f32 v25, v25
    v_exp_f32 v26, v26
    v_exp_f32 v27, v27
    v_exp_f32 v28, v28
    v_smfmac_f32_32x32x32_bf16 v[48:63], v[96:99], v[16:23], v112
    v_exp_f32 v29, v29
    v_exp_f32 v30, v30
    v_exp_f32 v31, v31
    v_exp_f32 v32, v32
    v_exp_f32 v33, v33
    v_exp_f32 v34, v34
    v_smfmac_f32_32x32x32_bf16 v[48:63], v[100:103], v[24:31], v112
    v_exp_f32 v35, v35
    v_exp_f32 v36, v36
    v_exp_f32 v37, v37
    v_exp_f32 v38, v38
    v_exp_f32 v39, v39
    s_waitcnt lgkmcnt(0)
    v_mfma_f32_32x32x16_bf16 v[16:31], v[92:95], v[80:83], 0
    v_exp_f32 v40, v40
    v_exp_f32 v41, v41
    v_exp_f32 v42, v42
    v_exp_f32 v43, v43
    v_exp_f32 v44, v44
    v_smfmac_f32_32x32x32_bf16 v[64:79], v[96:99], v[32:39], v112
    v_exp_f32 v45, v45
    v_exp_f32 v46, v46
    v_exp_f32 v47, v47
    s_waitcnt vmcnt(0)
    s_barrier
    s_add_u32 s63, s63, 16384
    s_cmp_eq_u32 s63, 81920
    s_cselect_b32 s63, 0, s63
    v_add_u32 v113, s63, v116
    v_add_u32 v114, s63, v117
    s_setprio 2
    v_exp_f32 v16, v16
    v_exp_f32 v17, v17
    v_exp_f32 v18, v18
    v_smfmac_f32_32x32x32_bf16 v[64:79], v[100:103], v[40:47], v112
    ds_read_b128 v[88:91], v113 offset:0
    s_mov_b64 exec, s[64:65]
    ds_read_b128 v[96:99], v114 offset:0
    ds_read_b128 v[100:103], v114 offset:512
    s_mov_b64 exec, -1
    v_exp_f32 v19, v19
    v_exp_f32 v20, v20
    v_exp_f32 v21, v21
    v_exp_f32 v22, v22
    v_exp_f32 v23, v23
    v_mfma_f32_32x32x16_bf16 v[32:47], v[92:95], v[84:87], 0
    v_exp_f32 v24, v24
    v_exp_f32 v25, v25
    v_exp_f32 v26, v26
    v_exp_f32 v27, v27
    v_exp_f32 v28, v28
    v_smfmac_f32_32x32x32_bf16 v[48:63], v[104:107], v[16:23], v112
    v_exp_f32 v29, v29
    v_exp_f32 v30, v30
    v_exp_f32 v31, v31
    v_exp_f32 v32, v32
    v_exp_f32 v33, v33
    v_exp_f32 v34, v34
    v_smfmac_f32_32x32x32_bf16 v[48:63], v[108:111], v[24:31], v112
    v_exp_f32 v35, v35
    v_exp_f32 v36, v36
    v_exp_f32 v37, v37
    v_exp_f32 v38, v38
    v_exp_f32 v39, v39
    s_waitcnt lgkmcnt(0)
    v_mfma_f32_32x32x16_bf16 v[16:31], v[88:91], v[80:83], 0
    v_exp_f32 v40, v40
    v_exp_f32 v41, v41
    v_exp_f32 v42, v42
    v_exp_f32 v43, v43
    v_exp_f32 v44, v44
    v_smfmac_f32_32x32x32_bf16 v[64:79], v[104:107], v[32:39], v112
    s_cmp_gt_u32 s58, 1
    s_cbranch_scc1 A_rf0
    s_add_u32 m0, s54, s49
    s_add_u32 s50, s57, s56
    buffer_load_dwordx4 v115, s[24:27], s50 offen sc1 lds
    buffer_load_dwordx4 v115, s[24:27], s50 offen offset:1024 sc1 lds
    s_add_u32 s56, s56, 16384
    s_and_b32 s56, s56, 0x1ffff
    s_add_u32 s54, s54, 16384
    s_cmp_eq_u32 s54, 81920
    s_cselect_b32 s54, 0, s54
A_rf0:
    v_exp_f32 v45, v45
    v_exp_f32 v46, v46
    v_exp_f32 v47, v47
    s_add_u32 s58, s58, 1
    s_cmp_lt_u32 s58, 4
    s_cbranch_scc1 A_loop
    s_nop 1
    v_smfmac_f32_32x32x32_bf16 v[64:79], v[108:111], v[40:47], v112
A_fin:
    s_setprio 3
    s_lshr_b32 s53, s3, 2
    s_lshl_b32 s51, s3, 12
    s_xor_b32 s52, s51, 16384
    v_add_u32 v10, s51, v119
    v_add_u32 v11, s52, v119
    s_nop 5
    s_cmp_lg_u32 s53, 0
    s_cbranch_scc1 A_hi
    ds_write_b128 v10, v[64:67] offset:0
    ds_write_b128 v10, v[68:71] offset:1024
    ds_write_b128 v10, v[72:75] offset:2048
    s_branch A_x
A_hi:
    ds_write_b128 v10, v[48:51] offset:0
    ds_write_b128 v10, v[52:55] offset:1024
    ds_write_b128 v10, v[56:59] offset:2048
    s_nop 1
    v_mov_b32 v48, v64
    v_mov_b32 v49, v65
    v_mov_b32 v50, v66
    v_mov_b32 v51, v67
    v_mov_b32 v52, v68
    v_mov_b32 v53, v69
    v_mov_b32 v54, v70
    v_mov_b32 v55, v71
    v_mov_b32 v56, v72
A_x:
    s_waitcnt lgkmcnt(0)
    s_barrier
    ds_read_b128 v[24:27], v11 offset:2048
    ds_read_b128 v[16:19], v11
    ds_read_b128 v[20:23], v11 offset:1024
    s_waitcnt lgkmcnt(2)
A_noex:
    v_add_f32 v12, v56, v24
    v_rcp_f32 v12, v12
    s_waitcnt lgkmcnt(0)
    v_add_f32 v48, v48, v16
    v_add_f32 v49, v49, v17
    v_add_f32 v50, v50, v18
    v_add_f32 v51, v51, v19
    v_add_f32 v52, v52, v20
    v_add_f32 v53, v53, v21
    v_add_f32 v54, v54, v22
    v_add_f32 v55, v55, v23
    v_mul_f32 v48, v12, v48
    v_mul_f32 v49, v12, v49
    v_mul_f32 v50, v12, v50
    v_mul_f32 v51, v12, v51
    v_mul_f32 v52, v12, v52
    v_mul_f32 v53, v12, v53
    v_mul_f32 v54, v12, v54
    v_mul_f32 v55, v12, v55
    v_cvt_pk_bf16_f32 v32, v48, v49
    v_cvt_pk_bf16_f32 v33, v50, v51
    v_cvt_pk_bf16_f32 v34, v52, v53
    v_cvt_pk_bf16_f32 v35, v54, v55
    buffer_store_dwordx4 v[32:35], v119, s[24:27], s5 offen sc0 sc1
    s_waitcnt vmcnt(0)
    s_mov_b64 exec, 1
    v_mov_b32 v10, 0
    v_mov_b32 v11, s48
    buffer_store_dword v11, v10, s[24:27], s6 offen sc0 sc1
    s_mov_b64 exec, -1
    s_endpgm
A_slow:
    v_mov_b32 v4, 0xff7fffff
    v_mov_b32 v5, 0xff7fffff
A_sloop:
    s_mov_b32 s53, 0
A_stile:
    ds_read_b128 v[88:91], v113
    s_mov_b64 exec, s[64:65]
    ds_read_b128 v[96:99], v114 offset:0
    ds_read_b128 v[100:103], v114 offset:512
    s_mov_b64 exec, -1
    v_add_u32 v113, 4096, v113
    v_add_u32 v114, 4096, v114
    s_waitcnt lgkmcnt(0)
    v_mfma_f32_32x32x16_bf16 v[16:31], v[88:91], v[80:83], 0
    s_nop 15
    v_max3_f32 v6, v16, v17, v4
    v_max3_f32 v6, v18, v19, v6
    v_max3_f32 v6, v20, v21, v6
    v_max3_f32 v6, v22, v23, v6
    v_max3_f32 v6, v24, v25, v6
    v_max3_f32 v6, v26, v27, v6
    v_max3_f32 v6, v28, v29, v6
    v_max3_f32 v6, v30, v31, v6
    v_mov_b32 v7, v6
    s_nop 1
    v_permlane32_swap_b32 v6, v7
    s_nop 1
    v_max_f32 v6, v6, v7
    v_sub_f32 v7, v4, v6
    v_exp_f32 v7, v7
    v_mov_b32 v4, v6
    v_sub_f32 v16, v16, v6
    v_sub_f32 v17, v17, v6
    v_sub_f32 v18, v18, v6
    v_sub_f32 v19, v19, v6
    v_sub_f32 v20, v20, v6
    v_sub_f32 v21, v21, v6
    v_sub_f32 v22, v22, v6
    v_sub_f32 v23, v23, v6
    v_sub_f32 v24, v24, v6
    v_sub_f32 v25, v25, v6
    v_sub_f32 v26, v26, v6
    v_sub_f32 v27, v27, v6
    v_sub_f32 v28, v28, v6
    v_sub_f32 v29, v29, v6
    v_sub_f32 v30, v30, v6
    v_sub_f32 v31, v31, v6
    v_exp_f32 v16, v16
    v_exp_f32 v17, v17
    v_exp_f32 v18, v18
    v_exp_f32 v19, v19
    v_exp_f32 v20, v20
    v_exp_f32 v21, v21
    v_exp_f32 v22, v22
    v_exp_f32 v23, v23
    v_exp_f32 v24, v24
    v_exp_f32 v25, v25
    v_exp_f32 v26, v26
    v_exp_f32 v27, v27
    v_exp_f32 v28, v28
    v_exp_f32 v29, v29
    v_exp_f32 v30, v30
    v_exp_f32 v31, v31
    v_mul_f32 v48, v7, v48
    v_mul_f32 v49, v7, v49
    v_mul_f32 v50, v7, v50
    v_mul_f32 v51, v7, v51
    v_mul_f32 v52, v7, v52
    v_mul_f32 v53, v7, v53
    v_mul_f32 v54, v7, v54
    v_mul_f32 v55, v7, v55
    v_mul_f32 v56, v7, v56
    s_nop 1
    v_smfmac_f32_32x32x32_bf16 v[48:63], v[96:99], v[16:23], v112
    v_smfmac_f32_32x32x32_bf16 v[48:63], v[100:103], v[24:31], v112
    v_mfma_f32_32x32x16_bf16 v[16:31], v[88:91], v[84:87], 0
    s_nop 15
    v_max3_f32 v6, v16, v17, v5
    v_max3_f32 v6, v18, v19, v6
    v_max3_f32 v6, v20, v21, v6
    v_max3_f32 v6, v22, v23, v6
    v_max3_f32 v6, v24, v25, v6
    v_max3_f32 v6, v26, v27, v6
    v_max3_f32 v6, v28, v29, v6
    v_max3_f32 v6, v30, v31, v6
    v_mov_b32 v7, v6
    s_nop 1
    v_permlane32_swap_b32 v6, v7
    s_nop 1
    v_max_f32 v6, v6, v7
    v_sub_f32 v7, v5, v6
    v_exp_f32 v7, v7
    v_mov_b32 v5, v6
    v_sub_f32 v16, v16, v6
    v_sub_f32 v17, v17, v6
    v_sub_f32 v18, v18, v6
    v_sub_f32 v19, v19, v6
    v_sub_f32 v20, v20, v6
    v_sub_f32 v21, v21, v6
    v_sub_f32 v22, v22, v6
    v_sub_f32 v23, v23, v6
    v_sub_f32 v24, v24, v6
    v_sub_f32 v25, v25, v6
    v_sub_f32 v26, v26, v6
    v_sub_f32 v27, v27, v6
    v_sub_f32 v28, v28, v6
    v_sub_f32 v29, v29, v6
    v_sub_f32 v30, v30, v6
    v_sub_f32 v31, v31, v6
    v_exp_f32 v16, v16
    v_exp_f32 v17, v17
    v_exp_f32 v18, v18
    v_exp_f32 v19, v19
    v_exp_f32 v20, v20
    v_exp_f32 v21, v21
    v_exp_f32 v22, v22
    v_exp_f32 v23, v23
    v_exp_f32 v24, v24
    v_exp_f32 v25, v25
    v_exp_f32 v26, v26
    v_exp_f32 v27, v27
    v_exp_f32 v28, v28
    v_exp_f32 v29, v29
    v_exp_f32 v30, v30
    v_exp_f32 v31, v31
    v_mul_f32 v64, v7, v64
    v_mul_f32 v65, v7, v65
    v_mul_f32 v66, v7, v66
    v_mul_f32 v67, v7, v67
    v_mul_f32 v68, v7, v68
    v_mul_f32 v69, v7, v69
    v_mul_f32 v70, v7, v70
    v_mul_f32 v71, v7, v71
    v_mul_f32 v72, v7, v72
    s_nop 1
    v_smfmac_f32_32x32x32_bf16 v[64:79], v[96:99], v[16:23], v112
    v_smfmac_f32_32x32x32_bf16 v[64:79], v[100:103], v[24:31], v112
    s_add_u32 s53, s53, 1
    s_cmp_lt_u32 s53, 4
    s_cbranch_scc1 A_stile
    s_waitcnt vmcnt(0)
    s_barrier
    s_cmp_gt_u32 s58, 5
    s_cbranch_scc1 A_nf1927
    s_add_u32 m0, s54, s49
    s_add_u32 s50, s57, s56
    buffer_load_dwordx4 v115, s[24:27], s50 offen sc1 lds
    buffer_load_dwordx4 v115, s[24:27], s50 offen offset:1024 sc1 lds
    s_add_u32 s56, s56, 16384
    s_and_b32 s56, s56, 0x1ffff
    s_add_u32 s54, s54, 16384
    s_cmp_eq_u32 s54, 81920
    s_cselect_b32 s54, 0, s54
A_nf1927:
    s_add_u32 s63, s63, 16384
    s_cmp_eq_u32 s63, 81920
    s_cselect_b32 s63, 0, s63
    v_add_u32 v113, s63, v116
    v_add_u32 v114, s63, v117
    s_add_u32 s58, s58, 1
    s_cmp_lt_u32 s58, 8
    s_cbranch_scc1 A_sloop
    s_lshl_b32 s51, s3, 10
    s_add_u32 s51, s51, 65536
    s_xor_b32 s52, s51, 4096
    v_add_u32 v10, s51, v119
    v_add_u32 v11, s52, v119
    ds_write_b64 v10, v[4:5]
    s_waitcnt lgkmcnt(0)
    s_barrier
    ds_read_b64 v[6:7], v11
    s_waitcnt lgkmcnt(0)
    v_max_f32 v6, v6, v4
    v_sub_f32 v6, v4, v6
    v_exp_f32 v6, v6
    s_nop 0
    v_mul_f32 v48, v6, v48
    v_mul_f32 v49, v6, v49
    v_mul_f32 v50, v6, v50
    v_mul_f32 v51, v6, v51
    v_mul_f32 v52, v6, v52
    v_mul_f32 v53, v6, v53
    v_mul_f32 v54, v6, v54
    v_mul_f32 v55, v6, v55
    v_mul_f32 v56, v6, v56
    v_max_f32 v7, v7, v5
    v_sub_f32 v7, v5, v7
    v_exp_f32 v7, v7
    s_nop 0
    v_mul_f32 v64, v7, v64
    v_mul_f32 v65, v7, v65
    v_mul_f32 v66, v7, v66
    v_mul_f32 v67, v7, v67
    v_mul_f32 v68, v7, v68
    v_mul_f32 v69, v7, v69
    v_mul_f32 v70, v7, v70
    v_mul_f32 v71, v7, v71
    v_mul_f32 v72, v7, v72
    s_branch A_fin
F_main:
    s_mov_b32 s14, 0x200000
    s_mov_b32 s15, 0x20000
    s_mov_b32 s18, 0x1c0000
    s_mov_b32 s19, 0x20000
    s_mov_b32 s22, 0x1c0000
    s_mov_b32 s23, 0x20000
    s_mov_b32 s26, 0x1100000
    s_mov_b32 s27, 0x20000
    s_mov_b32 s30, 0x100
    s_mov_b32 s31, 0x20000
    s_mov_b32 s34, 0x1c0000
    s_mov_b32 s35, 0x20000
    s_mov_b32 s38, 0x80000
    s_mov_b32 s39, 0x20000
    s_mov_b32 s42, 0x200000
    s_mov_b32 s43, 0x20000
    s_mov_b32 s46, 0x400
    s_mov_b32 s47, 0x20000
    s_lshl_b32 s49, s3, 10
    s_setprio 0
    v_lshrrev_b32 v9, 3, v0
    v_lshrrev_b32 v10, 4, v0
    v_xor_b32 v11, v10, v0
    v_and_b32 v11, 7, v11
    v_lshlrev_b32 v11, 4, v11
    v_lshl_add_u32 v1, v9, 10, v11
    s_waitcnt lgkmcnt(0)
    s_and_b32 s65, s2, 1
    s_lshr_b32 s51, s61, 2
    s_lshl_b32 s58, s51, 3
    s_mul_i32 s52, s51, 6
    s_add_u32 s52, s52, 64
    s_and_b32 s53, s52, 2
    s_and_b32 s52, s52, 0xfc
    s_cmp_eq_u32 s65, 1
    s_cselect_b32 s58, s52, s58
    s_cselect_b32 s53, s53, 0
    s_and_b32 s57, s3, 6
    s_cmp_eq_u32 s57, 6
    s_cselect_b32 s52, s65, 0
    s_sub_u32 s57, s57, s52
    s_add_u32 s57, s57, s53
    s_lshl_b32 s60, s65, 3
    s_add_u32 s60, s60, s51
    s_and_b32 s50, s61, 3
    s_and_b32 s59, s2, 6
    s_lshl_b32 s59, s59, 1
    s_add_u32 s59, s59, s50
    s_mov_b32 s54, 0
    s_mov_b32 s56, 0
    s_lshl_b32 s55, s59, 17
    s_lshl_b32 s51, s51, 2
    s_and_b32 s50, s3, 3
    s_add_u32 s51, s51, s50
    s_lshl_b32 s51, s51, 12
    s_add_u32 s64, s51, s55
    s_lshl_b32 s50, s61, 2
    s_and_b32 s51, s3, 3
    s_add_u32 s50, s50, s51
    s_mul_i32 s50, s50, 3584
    s_lshl_b32 s51, s65, 11
    s_add_u32 s50, s50, s51
    s_mov_b32 s52, 458752
    v_bfe_u32 v12, v0, 4, 2
    v_mul_u32_u24 v12, s52, v12
    v_and_b32 v13, 15, v0
    v_lshl_add_u32 v12, v13, 7, v12
    v_add_u32 v13, s50, v12
    s_cmp_lt_u32 s3, 4
    s_cselect_b32 s4, s16, s20
    s_cselect_b32 s5, s17, s21
    s_mov_b32 s6, 1835008
    s_mov_b32 s7, 0x20000
    s_cmp_eq_u32 s65, 1
    s_cselect_b32 s53, 0x0fff0fff, -1
    s_mov_b64 exec, 1
    s_mov_b32 exec_lo, s53
    buffer_load_dword v127, v13, s[4:7], 0 offen
    s_mov_b64 exec, -1
    s_mov_b32 s54, s60
    s_and_b32 s8, s2, 7
    s_xor_b32 s8, s8, 2
    s_lshl_b32 s8, s8, 2
    s_and_b32 s51, s61, 3
    s_add_u32 s8, s8, s51
    s_lshr_b32 s60, s61, 2
    s_mul_i32 s10, s8, 294912
    s_add_u32 s10, s10, 0x600000
    v_and_b32 v48, 63, v0
    v_lshlrev_b32 v48, 4, v48
    s_and_b32 s50, s3, 1
    s_lshr_b32 s52, s3, 1
    s_mul_i32 s51, s50, 144
    s_add_u32 s51, s51, s52
    s_lshl_b32 s51, s51, 10
    v_add_u32 v49, s51, v48
    s_lshl_b32 s51, s50, 2
    s_add_u32 s51, s51, s52
    s_lshl_b32 s9, s51, 10
    v_bfe_u32 v12, v0, 4, 1
    v_lshlrev_b32 v13, 2, v12
    v_xor_b32 v13, v13, v0
    v_and_b32 v13, 7, v13
    v_lshlrev_b32 v13, 4, v13
    v_lshl_add_u32 v13, v9, 10, v13
    s_lshl_b32 s51, s60, 7
    v_add_u32 v50, s51, v13
    s_lshr_b32 s53, s3, 2
    s_lshl_b32 s51, s50, 12
    s_lshl_b32 s52, s53, 11
    s_add_u32 s51, s51, s52
    v_add_u32 v51, s51, v48
    v_bfe_u32 v13, v0, 2, 2
    v_bfe_u32 v14, v0, 5, 1
    v_lshl_add_u32 v15, v14, 2, v13
    v_lshlrev_b32 v15, 7, v15
    v_lshrrev_b32 v13, 1, v13
    v_bfe_u32 v56, v0, 7, 1
    v_xor_b32 v13, v13, v56
    v_lshl_add_u32 v15, v13, 6, v15
    v_lshl_add_u32 v15, v12, 5, v15
    v_and_b32 v13, 3, v0
    v_lshl_add_u32 v15, v13, 3, v15
    s_lshl_b32 s51, s53, 12
    s_add_u32 s51, s51, 8192
    v_add_u32 v52, s51, v15
    v_add_u32 v53, 0x10000, v51
    v_add_u32 v54, 0x10000, v52
    s_lshl_b32 s51, s53, 15
    v_add_u32 v55, s51, v15
    v_and_b32 v13, 31, v0
    v_bfe_u32 v15, v0, 6, 1
    v_lshl_add_u32 v13, v15, 5, v13
    v_lshlrev_b32 v57, 2, v13
    v_lshlrev_b32 v13, 10, v13
    v_lshl_add_u32 v13, v14, 4, v13
    v_lshl_add_u32 v13, v56, 6, v13
    s_lshl_b32 s51, s53, 5
    v_add_u32 v58, s51, v13
    s_lshl_b32 s98, s8, 16
    s_lshl_b32 s51, s60, 7
    s_add_u32 s98, s98, s51
    s_lshl_b32 s67, s8, 8
    s_add_u32 s67, s67, 0xf04000
    s_lshl_b32 s51, s60, 3
    s_add_u32 s51, s51, s3
    s_mul_i32 s51, s51, 1792
    s_add_u32 s11, s51, s10
    v_and_b32 v13, 15, v0
    v_lshlrev_b32 v62, 6, v13
    v_lshlrev_b32 v13, 7, v13
    v_mul_u32_u24 v12, 147456, v12
    v_add_u32 v56, v13, v12
    s_lshl_b32 s51, s3, 11
    s_add_u32 s51, s51, 65536
    s_xor_b32 s52, s51, 8192
    v_add_u32 v59, s51, v48
    v_add_u32 v60, s52, v48
    s_bfe_u32 s52, s3, 0x10001
    s_lshl_b32 s52, s52, 4
    s_add_u32 s52, s52, s53
    s_lshl_b32 s96, s50, 5
    s_add_u32 s96, s96, s52
    s_lshl_b32 s96, s96, 10
    s_mul_i32 s51, s50, 144
    s_add_u32 s51, s51, s52
    s_add_u32 s51, s51, 112
    s_lshl_b32 s51, s51, 10
    s_add_u32 s97, s10, s51
    s_lshl_b32 s50, s50, 15
    s_lshl_b32 s53, s53, 14
    s_add_u32 s50, s50, s53
    v_add_u32 v61, s50, v48
    v_lshlrev_b32 v63, 6, v0
    s_lshr_b32 s99, s8, 1
    s_lshl_b32 s99, s99, 10
    s_add_u32 s99, s99, 0xf0c000
    s_lshl_b32 s100, s8, 12
    s_add_u32 s100, s100, 0xf20000
    s_mov_b32 s60, s54
    s_mov_b32 s54, 0
    v_mul_u32_u24 v9, 3584, v10
    v_bfe_u32 v11, v0, 1, 3
    v_and_b32 v10, 3, v10
    v_xor_b32 v11, v11, v10
    v_lshl_add_u32 v9, v11, 5, v9
    v_and_b32 v11, 1, v0
    v_lshl_add_u32 v9, v11, 4, v9
    s_lshl_b32 s50, s58, 5
    v_add_u32 v2, s50, v9
    v_xor_b32 v3, 128, v9
    v_add_u32 v3, s50, v3
    v_and_b32 v8, 31, v0
    v_lshrrev_b32 v9, 1, v8
    v_and_b32 v9, 7, v9
    v_bfe_u32 v10, v0, 5, 1
    v_xor_b32 v9, v9, v10
    v_lshlrev_b32 v9, 4, v9
    v_lshl_add_u32 v9, v8, 7, v9
    v_bfe_u32 v8, v0, 6, 1
    v_lshl_add_u32 v4, v8, 13, v9
    v_xor_b32 v5, 32, v4
    v_xor_b32 v6, 64, v4
    v_xor_b32 v7, 96, v4
    v_bfe_u32 v8, v0, 2, 2
    v_lshl_add_u32 v9, v10, 3, v8
    v_lshlrev_b32 v9, 8, v9
    v_bfe_u32 v10, v0, 4, 1
    v_lshl_add_u32 v9, v10, 13, v9
    v_lshlrev_b32 v10, 2, v10
    v_xor_b32 v8, v8, v10
    v_xor_b32 v8, s57, v8
    v_lshl_add_u32 v9, v8, 5, v9
    v_and_b32 v8, 3, v0
    v_lshl_add_u32 v9, v8, 3, v9
    v_add_u32 v8, 32768, v9
    v_xor_b32 v9, 32, v8
    s_and_b32 s50, s3, 1
    s_lshl_b32 s50, s50, 1
    s_lshl_b32 s51, s59, 2
    s_add_u32 s50, s50, s51
    s_mul_i32 s50, s50, 144
    s_add_u32 s50, s50, s58
    s_add_u32 s50, s50, s57
    s_lshl_b32 s50, s50, 10
    s_add_u32 s101, s50, 0x600000
    s_add_u32 s63, s101, 147456
    s_lshl_b32 s50, s59, 10
    s_lshl_b32 s51, s60, 6
    s_add_u32 s50, s50, s51
    s_add_u32 s62, s50, 0xf0c000
    v_mov_b32 v12, 1.0
    v_lshlrev_b32 v13, 3, v48
    v_and_b32 v14, 0xf0, v48
    v_bfe_u32 v15, v0, 4, 2
    s_cmp_lg_u32 s3, 0
    s_cbranch_scc1 F_go
    s_mov_b32 s66, 0x40000
    v_mov_b32 v10, 0
F_tag_t:
    buffer_load_dword v11, v10, s[28:31], 0 offen sc1
    s_waitcnt vmcnt(0)
    v_readfirstlane_b32 s48, v11
    s_nop 3
    s_cmp_lg_u32 s48, 0
    s_cbranch_scc1 F_tag_t_ok
    s_sleep 16
    s_sub_u32 s66, s66, 1
    s_cmp_lg_u32 s66, 0
    s_cbranch_scc1 F_tag_t
F_tag_t_ok:
    v_mov_b32 v10, 0
    s_and_b32 s50, s2, 7
    s_xor_b32 s50, s50, 1
    s_lshl_b32 s50, s50, 7
    s_add_u32 s50, s50, 0xf07400
    s_mov_b32 s66, 0x40000
F_tag:
    buffer_load_dword v11, v10, s[24:27], s50 offen sc1
    s_waitcnt vmcnt(0)
    v_cmp_ne_u32 vcc, s48, v11
    s_nop 4
    s_cmp_eq_u64 vcc, 0
    s_cbranch_scc1 F_tag_ok
    s_sleep 2
    s_sub_u32 s66, s66, 1
    s_cmp_lg_u32 s66, 0
    s_cbranch_scc1 F_tag
F_tag_ok:
F_go:
    s_barrier
    s_add_u32 m0, s49, 0
    s_add_u32 s50, s55, s54
    buffer_load_dwordx4 v1, s[12:15], s50 offen lds
    s_add_u32 m0, s49, 8192
    s_add_u32 s50, s50, 0x10000
    buffer_load_dwordx4 v1, s[12:15], s50 offen lds
    s_add_u32 s54, s54, 128
    s_and_b32 s54, s54, 1023
    s_add_u32 m0, s49, 32768
    s_nop 0
    buffer_load_dwordx4 v2, s[16:19], s56 offen lds
    s_add_u32 m0, s49, 40960
    s_nop 0
    buffer_load_dwordx4 v3, s[20:23], s56 offen lds
    s_add_u32 s56, s56, 114688
    s_cmp_eq_u32 s56, 1835008
    s_cselect_b32 s56, 0, s56
    s_add_u32 m0, s49, 49152
    s_nop 0
    buffer_load_dwordx4 v2, s[16:19], s56 offen lds
    s_add_u32 m0, s49, 57344
    s_nop 0
    buffer_load_dwordx4 v3, s[20:23], s56 offen lds
    s_add_u32 s56, s56, 114688
    s_cmp_eq_u32 s56, 1835008
    s_cselect_b32 s56, 0, s56
    s_add_u32 m0, s49, 16384
    s_add_u32 s50, s55, s54
    buffer_load_dwordx4 v1, s[12:15], s50 offen lds
    s_add_u32 m0, s49, 24576
    s_add_u32 s50, s50, 0x10000
    buffer_load_dwordx4 v1, s[12:15], s50 offen lds
    s_add_u32 s54, s54, 128
    s_and_b32 s54, s54, 1023
    s_add_u32 m0, s49, 65536
    s_nop 0
    buffer_load_dwordx4 v2, s[16:19], s56 offen lds
    s_add_u32 m0, s49, 73728
    s_nop 0
    buffer_load_dwordx4 v3, s[20:23], s56 offen lds
    s_add_u32 s56, s56, 114688
    s_cmp_eq_u32 s56, 1835008
    s_cselect_b32 s56, 0, s56
    s_setprio 3
    s_waitcnt vmcnt(6)
    s_barrier
    s_lshr_b32 s50, s3, 2
    s_and_b32 s50, s50, s65
    s_cbranch_scc1 F_one
    ds_read_b128 v[16:19], v4 offset:0
    ds_read_b64_tr_b16 v[24:25], v8 offset:0
    ds_read_b64_tr_b16 v[26:27], v8 offset:1024
    ds_read_b128 v[20:23], v4 offset:4096
    ds_read_b64_tr_b16 v[28:29], v9 offset:0
    ds_read_b64_tr_b16 v[30:31], v9 offset:1024
    s_waitcnt lgkmcnt(0)
    v_mfma_f32_32x32x16_bf16 v[64:79], v[24:27], v[16:19], 0
    ds_read_b128 v[32:35], v5 offset:0
    ds_read_b64_tr_b16 v[40:41], v8 offset:4096
    ds_read_b64_tr_b16 v[42:43], v8 offset:5120
    v_mfma_f32_32x32x16_bf16 v[80:95], v[28:31], v[16:19], 0
    ds_read_b128 v[36:39], v5 offset:4096
    ds_read_b64_tr_b16 v[44:45], v9 offset:4096
    ds_read_b64_tr_b16 v[46:47], v9 offset:5120
    v_mfma_f32_32x32x16_bf16 v[112:127], v[28:31], v[20:23], 0
    v_mfma_f32_32x32x16_bf16 v[96:111], v[24:27], v[20:23], 0
    s_waitcnt vmcnt(4) lgkmcnt(0)
    s_barrier
    v_mfma_f32_32x32x16_bf16 v[64:79], v[40:43], v[32:35], v[64:79]
    ds_read_b128 v[16:19], v6 offset:0
    ds_read_b64_tr_b16 v[24:25], v8 offset:16384
    ds_read_b64_tr_b16 v[26:27], v8 offset:17408
    v_mfma_f32_32x32x16_bf16 v[80:95], v[44:47], v[32:35], v[80:95]
    ds_read_b128 v[20:23], v6 offset:4096
    ds_read_b64_tr_b16 v[28:29], v9 offset:16384
    ds_read_b64_tr_b16 v[30:31], v9 offset:17408
    v_mfma_f32_32x32x16_bf16 v[112:127], v[44:47], v[36:39], v[112:127]
    s_add_u32 m0, s49, 32768
    s_nop 0
    buffer_load_dwordx4 v2, s[16:19], s56 offen lds
    s_add_u32 m0, s49, 40960
    s_nop 0
    buffer_load_dwordx4 v3, s[20:23], s56 offen lds
    s_add_u32 s56, s56, 114688
    s_cmp_eq_u32 s56, 1835008
    s_cselect_b32 s56, 0, s56
    v_mfma_f32_32x32x16_bf16 v[96:111], v[40:43], v[36:39], v[96:111]
    s_waitcnt lgkmcnt(0)
    v_mfma_f32_32x32x16_bf16 v[64:79], v[24:27], v[16:19], v[64:79]
    ds_read_b128 v[32:35], v7 offset:0
    ds_read_b64_tr_b16 v[40:41], v8 offset:20480
    ds_read_b64_tr_b16 v[42:43], v8 offset:21504
    v_mfma_f32_32x32x16_bf16 v[80:95], v[28:31], v[16:19], v[80:95]
    ds_read_b128 v[36:39], v7 offset:4096
    ds_read_b64_tr_b16 v[44:45], v9 offset:20480
    ds_read_b64_tr_b16 v[46:47], v9 offset:21504
    v_mfma_f32_32x32x16_bf16 v[112:127], v[28:31], v[20:23], v[112:127]
    v_mfma_f32_32x32x16_bf16 v[96:111], v[24:27], v[20:23], v[96:111]
    s_waitcnt vmcnt(2) lgkmcnt(0)
    s_barrier
    v_mfma_f32_32x32x16_bf16 v[64:79], v[40:43], v[32:35], v[64:79]
    ds_read_b128 v[16:19], v4 offset:16384
    ds_read_b64_tr_b16 v[24:25], v8 offset:32768
    ds_read_b64_tr_b16 v[26:27], v8 offset:33792
    v_mfma_f32_32x32x16_bf16 v[80:95], v[44:47], v[32:35], v[80:95]
    ds_read_b128 v[20:23], v4 offset:20480
    ds_read_b64_tr_b16 v[28:29], v9 offset:32768
    ds_read_b64_tr_b16 v[30:31], v9 offset:33792
    v_mfma_f32_32x32x16_bf16 v[112:127], v[44:47], v[36:39], v[112:127]
    s_add_u32 m0, s49, 49152
    s_nop 0
    buffer_load_dwordx4 v2, s[16:19], s56 offen lds
    s_add_u32 m0, s49, 57344
    s_nop 0
    buffer_load_dwordx4 v3, s[20:23], s56 offen lds
    s_add_u32 s56, s56, 114688
    s_cmp_eq_u32 s56, 1835008
    s_cselect_b32 s56, 0, s56
    v_mfma_f32_32x32x16_bf16 v[96:111], v[40:43], v[36:39], v[96:111]
    s_add_u32 m0, s49, 0
    s_add_u32 s50, s55, s54
    buffer_load_dwordx4 v1, s[12:15], s50 offen lds
    s_add_u32 m0, s49, 8192
    s_add_u32 s50, s50, 0x10000
    buffer_load_dwordx4 v1, s[12:15], s50 offen lds
    s_add_u32 s54, s54, 128
    s_and_b32 s54, s54, 1023
    s_waitcnt lgkmcnt(0)
    v_mfma_f32_32x32x16_bf16 v[64:79], v[24:27], v[16:19], v[64:79]
    ds_read_b128 v[32:35], v5 offset:16384
    ds_read_b64_tr_b16 v[40:41], v8 offset:36864
    ds_read_b64_tr_b16 v[42:43], v8 offset:37888
    v_mfma_f32_32x32x16_bf16 v[80:95], v[28:31], v[16:19], v[80:95]
    ds_read_b128 v[36:39], v5 offset:20480
    ds_read_b64_tr_b16 v[44:45], v9 offset:36864
    ds_read_b64_tr_b16 v[46:47], v9 offset:37888
    v_mfma_f32_32x32x16_bf16 v[112:127], v[28:31], v[20:23], v[112:127]
    v_mfma_f32_32x32x16_bf16 v[96:111], v[24:27], v[20:23], v[96:111]
    s_waitcnt vmcnt(4) lgkmcnt(0)
    s_barrier
    v_mfma_f32_32x32x16_bf16 v[64:79], v[40:43], v[32:35], v[64:79]
    ds_read_b128 v[16:19], v6 offset:16384
    ds_read_b64_tr_b16 v[24:25], v8 offset:0
    ds_read_b64_tr_b16 v[26:27], v8 offset:1024
    v_mfma_f32_32x32x16_bf16 v[80:95], v[44:47], v[32:35], v[80:95]
    ds_read_b128 v[20:23], v6 offset:20480
    ds_read_b64_tr_b16 v[28:29], v9 offset:0
    ds_read_b64_tr_b16 v[30:31], v9 offset:1024
    v_mfma_f32_32x32x16_bf16 v[112:127], v[44:47], v[36:39], v[112:127]
    s_add_u32 m0, s49, 65536
    s_nop 0
    buffer_load_dwordx4 v2, s[16:19], s56 offen lds
    s_add_u32 m0, s49, 73728
    s_nop 0
    buffer_load_dwordx4 v3, s[20:23], s56 offen lds
    s_add_u32 s56, s56, 114688
    s_cmp_eq_u32 s56, 1835008
    s_cselect_b32 s56, 0, s56
    v_mfma_f32_32x32x16_bf16 v[96:111], v[40:43], v[36:39], v[96:111]
    s_waitcnt lgkmcnt(0)
    v_mfma_f32_32x32x16_bf16 v[64:79], v[24:27], v[16:19], v[64:79]
    ds_read_b128 v[32:35], v7 offset:16384
    ds_read_b64_tr_b16 v[40:41], v8 offset:4096
    ds_read_b64_tr_b16 v[42:43], v8 offset:5120
    v_mfma_f32_32x32x16_bf16 v[80:95], v[28:31], v[16:19], v[80:95]
    ds_read_b128 v[36:39], v7 offset:20480
    ds_read_b64_tr_b16 v[44:45], v9 offset:4096
    ds_read_b64_tr_b16 v[46:47], v9 offset:5120
    v_mfma_f32_32x32x16_bf16 v[112:127], v[28:31], v[20:23], v[112:127]
    v_mfma_f32_32x32x16_bf16 v[96:111], v[24:27], v[20:23], v[96:111]
    s_waitcnt vmcnt(2) lgkmcnt(0)
    s_barrier
    v_mfma_f32_32x32x16_bf16 v[64:79], v[40:43], v[32:35], v[64:79]
    ds_read_b128 v[16:19], v4 offset:0
    ds_read_b64_tr_b16 v[24:25], v8 offset:16384
    ds_read_b64_tr_b16 v[26:27], v8 offset:17408
    v_mfma_f32_32x32x16_bf16 v[80:95], v[44:47], v[32:35], v[80:95]
    ds_read_b128 v[20:23], v4 offset:4096
    ds_read_b64_tr_b16 v[28:29], v9 offset:16384
    ds_read_b64_tr_b16 v[30:31], v9 offset:17408
    v_mfma_f32_32x32x16_bf16 v[112:127], v[44:47], v[36:39], v[112:127]
    s_add_u32 m0, s49, 32768
    s_nop 0
    buffer_load_dwordx4 v2, s[16:19], s56 offen lds
    s_add_u32 m0, s49, 40960
    s_nop 0
    buffer_load_dwordx4 v3, s[20:23], s56 offen lds
    s_add_u32 s56, s56, 114688
    s_cmp_eq_u32 s56, 1835008
    s_cselect_b32 s56, 0, s56
    v_mfma_f32_32x32x16_bf16 v[96:111], v[40:43], v[36:39], v[96:111]
    s_add_u32 m0, s49, 16384
    s_add_u32 s50, s55, s54
    buffer_load_dwordx4 v1, s[12:15], s50 offen lds
    s_add_u32 m0, s49, 24576
    s_add_u32 s50, s50, 0x10000
    buffer_load_dwordx4 v1, s[12:15], s50 offen lds
    s_add_u32 s54, s54, 128
    s_and_b32 s54, s54, 1023
    s_waitcnt lgkmcnt(0)
    v_mfma_f32_32x32x16_bf16 v[64:79], v[24:27], v[16:19], v[64:79]
    ds_read_b128 v[32:35], v5 offset:0
    ds_read_b64_tr_b16 v[40:41], v8 offset:20480
    ds_read_b64_tr_b16 v[42:43], v8 offset:21504
    v_mfma_f32_32x32x16_bf16 v[80:95], v[28:31], v[16:19], v[80:95]
    ds_read_b128 v[36:39], v5 offset:4096
    ds_read_b64_tr_b16 v[44:45], v9 offset:20480
    ds_read_b64_tr_b16 v[46:47], v9 offset:21504
    v_mfma_f32_32x32x16_bf16 v[112:127], v[28:31], v[20:23], v[112:127]
    v_mfma_f32_32x32x16_bf16 v[96:111], v[24:27], v[20:23], v[96:111]
    s_waitcnt vmcnt(4) lgkmcnt(0)
    s_barrier
    v_mfma_f32_32x32x16_bf16 v[64:79], v[40:43], v[32:35], v[64:79]
    ds_read_b128 v[16:19], v6 offset:0
    ds_read_b64_tr_b16 v[24:25], v8 offset:32768
    ds_read_b64_tr_b16 v[26:27], v8 offset:33792
    v_mfma_f32_32x32x16_bf16 v[80:95], v[44:47], v[32:35], v[80:95]
    ds_read_b128 v[20:23], v6 offset:4096
    ds_read_b64_tr_b16 v[28:29], v9 offset:32768
    ds_read_b64_tr_b16 v[30:31], v9 offset:33792
    v_mfma_f32_32x32x16_bf16 v[112:127], v[44:47], v[36:39], v[112:127]
    s_add_u32 m0, s49, 49152
    s_nop 0
    buffer_load_dwordx4 v2, s[16:19], s56 offen lds
    s_add_u32 m0, s49, 57344
    s_nop 0
    buffer_load_dwordx4 v3, s[20:23], s56 offen lds
    s_add_u32 s56, s56, 114688
    s_cmp_eq_u32 s56, 1835008
    s_cselect_b32 s56, 0, s56
    v_mfma_f32_32x32x16_bf16 v[96:111], v[40:43], v[36:39], v[96:111]
    s_setprio 0
    s_waitcnt lgkmcnt(0)
    v_mfma_f32_32x32x16_bf16 v[64:79], v[24:27], v[16:19], v[64:79]
    ds_read_b128 v[32:35], v7 offset:0
    ds_read_b64_tr_b16 v[40:41], v8 offset:36864
    ds_read_b64_tr_b16 v[42:43], v8 offset:37888
    v_mfma_f32_32x32x16_bf16 v[80:95], v[28:31], v[16:19], v[80:95]
    ds_read_b128 v[36:39], v7 offset:4096
    ds_read_b64_tr_b16 v[44:45], v9 offset:36864
    ds_read_b64_tr_b16 v[46:47], v9 offset:37888
    v_mfma_f32_32x32x16_bf16 v[112:127], v[28:31], v[20:23], v[112:127]
    v_mfma_f32_32x32x16_bf16 v[96:111], v[24:27], v[20:23], v[96:111]
    s_waitcnt vmcnt(2) lgkmcnt(0)
    s_barrier
    v_mfma_f32_32x32x16_bf16 v[64:79], v[40:43], v[32:35], v[64:79]
    ds_read_b128 v[16:19], v4 offset:16384
    ds_read_b64_tr_b16 v[24:25], v8 offset:0
    ds_read_b64_tr_b16 v[26:27], v8 offset:1024
    v_mfma_f32_32x32x16_bf16 v[80:95], v[44:47], v[32:35], v[80:95]
    ds_read_b128 v[20:23], v4 offset:20480
    ds_read_b64_tr_b16 v[28:29], v9 offset:0
    ds_read_b64_tr_b16 v[30:31], v9 offset:1024
    v_mfma_f32_32x32x16_bf16 v[112:127], v[44:47], v[36:39], v[112:127]
    s_add_u32 m0, s49, 65536
    s_nop 0
    buffer_load_dwordx4 v2, s[16:19], s56 offen lds
    s_add_u32 m0, s49, 73728
    s_nop 0
    buffer_load_dwordx4 v3, s[20:23], s56 offen lds
    s_add_u32 s56, s56, 114688
    s_cmp_eq_u32 s56, 1835008
    s_cselect_b32 s56, 0, s56
    v_mfma_f32_32x32x16_bf16 v[96:111], v[40:43], v[36:39], v[96:111]
    s_add_u32 m0, s49, 0
    s_add_u32 s50, s55, s54
    buffer_load_dwordx4 v1, s[12:15], s50 offen lds
    s_add_u32 m0, s49, 8192
    s_add_u32 s50, s50, 0x10000
    buffer_load_dwordx4 v1, s[12:15], s50 offen lds
    s_add_u32 s54, s54, 128
    s_and_b32 s54, s54, 1023
    s_waitcnt lgkmcnt(0)
    v_mfma_f32_32x32x16_bf16 v[64:79], v[24:27], v[16:19], v[64:79]
    ds_read_b128 v[32:35], v5 offset:16384
    ds_read_b64_tr_b16 v[40:41], v8 offset:4096
    ds_read_b64_tr_b16 v[42:43], v8 offset:5120
    v_mfma_f32_32x32x16_bf16 v[80:95], v[28:31], v[16:19], v[80:95]
    ds_read_b128 v[36:39], v5 offset:20480
    ds_read_b64_tr_b16 v[44:45], v9 offset:4096
    ds_read_b64_tr_b16 v[46:47], v9 offset:5120
    v_mfma_f32_32x32x16_bf16 v[112:127], v[28:31], v[20:23], v[112:127]
    v_mfma_f32_32x32x16_bf16 v[96:111], v[24:27], v[20:23], v[96:111]
    s_waitcnt vmcnt(4) lgkmcnt(0)
    s_barrier
    v_mfma_f32_32x32x16_bf16 v[64:79], v[40:43], v[32:35], v[64:79]
    ds_read_b128 v[16:19], v6 offset:16384
    ds_read_b64_tr_b16 v[24:25], v8 offset:16384
    ds_read_b64_tr_b16 v[26:27], v8 offset:17408
    v_mfma_f32_32x32x16_bf16 v[80:95], v[44:47], v[32:35], v[80:95]
    ds_read_b128 v[20:23], v6 offset:20480
    ds_read_b64_tr_b16 v[28:29], v9 offset:16384
    ds_read_b64_tr_b16 v[30:31], v9 offset:17408
    v_mfma_f32_32x32x16_bf16 v[112:127], v[44:47], v[36:39], v[112:127]
    s_add_u32 m0, s49, 32768
    s_nop 0
    buffer_load_dwordx4 v2, s[16:19], s56 offen lds
    s_add_u32 m0, s49, 40960
    s_nop 0
    buffer_load_dwordx4 v3, s[20:23], s56 offen lds
    s_add_u32 s56, s56, 114688
    s_cmp_eq_u32 s56, 1835008
    s_cselect_b32 s56, 0, s56
    v_mfma_f32_32x32x16_bf16 v[96:111], v[40:43], v[36:39], v[96:111]
    s_waitcnt lgkmcnt(0)
    v_mfma_f32_32x32x16_bf16 v[64:79], v[24:27], v[16:19], v[64:79]
    ds_read_b128 v[32:35], v7 offset:16384
    ds_read_b64_tr_b16 v[40:41], v8 offset:20480
    ds_read_b64_tr_b16 v[42:43], v8 offset:21504
    v_mfma_f32_32x32x16_bf16 v[80:95], v[28:31], v[16:19], v[80:95]
    ds_read_b128 v[36:39], v7 offset:20480
    ds_read_b64_tr_b16 v[44:45], v9 offset:20480
    ds_read_b64_tr_b16 v[46:47], v9 offset:21504
    v_mfma_f32_32x32x16_bf16 v[112:127], v[28:31], v[20:23], v[112:127]
    v_mfma_f32_32x32x16_bf16 v[96:111], v[24:27], v[20:23], v[96:111]
    s_waitcnt vmcnt(2) lgkmcnt(0)
    s_barrier
    v_mfma_f32_32x32x16_bf16 v[64:79], v[40:43], v[32:35], v[64:79]
    ds_read_b128 v[16:19], v4 offset:0
    ds_read_b64_tr_b16 v[24:25], v8 offset:32768
    ds_read_b64_tr_b16 v[26:27], v8 offset:33792
    v_mfma_f32_32x32x16_bf16 v[80:95], v[44:47], v[32:35], v[80:95]
    ds_read_b128 v[20:23], v4 offset:4096
    ds_read_b64_tr_b16 v[28:29], v9 offset:32768
    ds_read_b64_tr_b16 v[30:31], v9 offset:33792
    v_mfma_f32_32x32x16_bf16 v[112:127], v[44:47], v[36:39], v[112:127]
    s_add_u32 m0, s49, 49152
    s_nop 0
    buffer_load_dwordx4 v2, s[16:19], s56 offen lds
    s_add_u32 m0, s49, 57344
    s_nop 0
    buffer_load_dwordx4 v3, s[20:23], s56 offen lds
    s_add_u32 s56, s56, 114688
    s_cmp_eq_u32 s56, 1835008
    s_cselect_b32 s56, 0, s56
    v_mfma_f32_32x32x16_bf16 v[96:111], v[40:43], v[36:39], v[96:111]
    s_add_u32 m0, s49, 16384
    s_add_u32 s50, s55, s54
    buffer_load_dwordx4 v1, s[12:15], s50 offen lds
    s_add_u32 m0, s49, 24576
    s_add_u32 s50, s50, 0x10000
    buffer_load_dwordx4 v1, s[12:15], s50 offen lds
    s_add_u32 s54, s54, 128
    s_and_b32 s54, s54, 1023
    s_waitcnt lgkmcnt(0)
    v_mfma_f32_32x32x16_bf16 v[64:79], v[24:27], v[16:19], v[64:79]
    ds_read_b128 v[32:35], v5 offset:0
    ds_read_b64_tr_b16 v[40:41], v8 offset:36864
    ds_read_b64_tr_b16 v[42:43], v8 offset:37888
    v_mfma_f32_32x32x16_bf16 v[80:95], v[28:31], v[16:19], v[80:95]
    ds_read_b128 v[36:39], v5 offset:4096
    ds_read_b64_tr_b16 v[44:45], v9 offset:36864
    ds_read_b64_tr_b16 v[46:47], v9 offset:37888
    v_mfma_f32_32x32x16_bf16 v[112:127], v[28:31], v[20:23], v[112:127]
    v_mfma_f32_32x32x16_bf16 v[96:111], v[24:27], v[20:23], v[96:111]
    s_waitcnt vmcnt(4) lgkmcnt(0)
    s_barrier
    v_mfma_f32_32x32x16_bf16 v[64:79], v[40:43], v[32:35], v[64:79]
    ds_read_b128 v[16:19], v6 offset:0
    ds_read_b64_tr_b16 v[24:25], v8 offset:0
    ds_read_b64_tr_b16 v[26:27], v8 offset:1024
    v_mfma_f32_32x32x16_bf16 v[80:95], v[44:47], v[32:35], v[80:95]
    ds_read_b128 v[20:23], v6 offset:4096
    ds_read_b64_tr_b16 v[28:29], v9 offset:0
    ds_read_b64_tr_b16 v[30:31], v9 offset:1024
    v_mfma_f32_32x32x16_bf16 v[112:127], v[44:47], v[36:39], v[112:127]
    s_add_u32 m0, s49, 65536
    s_nop 0
    buffer_load_dwordx4 v2, s[16:19], s56 offen lds
    s_add_u32 m0, s49, 73728
    s_nop 0
    buffer_load_dwordx4 v3, s[20:23], s56 offen lds
    s_add_u32 s56, s56, 114688
    s_cmp_eq_u32 s56, 1835008
    s_cselect_b32 s56, 0, s56
    v_mfma_f32_32x32x16_bf16 v[96:111], v[40:43], v[36:39], v[96:111]
    s_waitcnt lgkmcnt(0)
    v_mfma_f32_32x32x16_bf16 v[64:79], v[24:27], v[16:19], v[64:79]
    ds_read_b128 v[32:35], v7 offset:0
    ds_read_b64_tr_b16 v[40:41], v8 offset:4096
    ds_read_b64_tr_b16 v[42:43], v8 offset:5120
    v_mfma_f32_32x32x16_bf16 v[80:95], v[28:31], v[16:19], v[80:95]
    ds_read_b128 v[36:39], v7 offset:4096
    ds_read_b64_tr_b16 v[44:45], v9 offset:4096
    ds_read_b64_tr_b16 v[46:47], v9 offset:5120
    v_mfma_f32_32x32x16_bf16 v[112:127], v[28:31], v[20:23], v[112:127]
    v_mfma_f32_32x32x16_bf16 v[96:111], v[24:27], v[20:23], v[96:111]
    s_waitcnt vmcnt(2) lgkmcnt(0)
    s_barrier
    v_mfma_f32_32x32x16_bf16 v[64:79], v[40:43], v[32:35], v[64:79]
    ds_read_b128 v[16:19], v4 offset:16384
    ds_read_b64_tr_b16 v[24:25], v8 offset:16384
    ds_read_b64_tr_b16 v[26:27], v8 offset:17408
    v_mfma_f32_32x32x16_bf16 v[80:95], v[44:47], v[32:35], v[80:95]
    ds_read_b128 v[20:23], v4 offset:20480
    ds_read_b64_tr_b16 v[28:29], v9 offset:16384
    ds_read_b64_tr_b16 v[30:31], v9 offset:17408
    v_mfma_f32_32x32x16_bf16 v[112:127], v[44:47], v[36:39], v[112:127]
    s_add_u32 m0, s49, 32768
    s_nop 0
    buffer_load_dwordx4 v2, s[16:19], s56 offen lds
    s_add_u32 m0, s49, 40960
    s_nop 0
    buffer_load_dwordx4 v3, s[20:23], s56 offen lds
    s_add_u32 s56, s56, 114688
    s_cmp_eq_u32 s56, 1835008
    s_cselect_b32 s56, 0, s56
    v_mfma_f32_32x32x16_bf16 v[96:111], v[40:43], v[36:39], v[96:111]
    s_add_u32 m0, s49, 0
    s_add_u32 s50, s55, s54
    buffer_load_dwordx4 v1, s[12:15], s50 offen lds
    s_add_u32 m0, s49, 8192
    s_add_u32 s50, s50, 0x10000
    buffer_load_dwordx4 v1, s[12:15], s50 offen lds
    s_add_u32 s54, s54, 128
    s_and_b32 s54, s54, 1023
    s_lshl_b32 s50, s61, 3
    s_add_u32 s50, s50, s3
    s_mul_i32 s50, s50, 2048
    s_mov_b64 exec, 0xffff
    buffer_load_dword v11, v13, s[36:39], s50 offen
    s_mov_b64 exec, -1
    s_waitcnt lgkmcnt(0)
    v_mfma_f32_32x32x16_bf16 v[64:79], v[24:27], v[16:19], v[64:79]
    ds_read_b128 v[32:35], v5 offset:16384
    ds_read_b64_tr_b16 v[40:41], v8 offset:20480
    ds_read_b64_tr_b16 v[42:43], v8 offset:21504
    v_mfma_f32_32x32x16_bf16 v[80:95], v[28:31], v[16:19], v[80:95]
    ds_read_b128 v[36:39], v5 offset:20480
    ds_read_b64_tr_b16 v[44:45], v9 offset:20480
    ds_read_b64_tr_b16 v[46:47], v9 offset:21504
    v_mfma_f32_32x32x16_bf16 v[112:127], v[28:31], v[20:23], v[112:127]
    v_mfma_f32_32x32x16_bf16 v[96:111], v[24:27], v[20:23], v[96:111]
    s_waitcnt vmcnt(5) lgkmcnt(0)
    s_barrier
    v_mfma_f32_32x32x16_bf16 v[64:79], v[40:43], v[32:35], v[64:79]
    ds_read_b128 v[16:19], v6 offset:16384
    ds_read_b64_tr_b16 v[24:25], v8 offset:32768
    ds_read_b64_tr_b16 v[26:27], v8 offset:33792
    v_mfma_f32_32x32x16_bf16 v[80:95], v[44:47], v[32:35], v[80:95]
    ds_read_b128 v[20:23], v6 offset:20480
    ds_read_b64_tr_b16 v[28:29], v9 offset:32768
    ds_read_b64_tr_b16 v[30:31], v9 offset:33792
    v_mfma_f32_32x32x16_bf16 v[112:127], v[44:47], v[36:39], v[112:127]
    s_add_u32 m0, s49, 49152
    s_nop 0
    buffer_load_dwordx4 v2, s[16:19], s56 offen lds
    s_add_u32 m0, s49, 57344
    s_nop 0
    buffer_load_dwordx4 v3, s[20:23], s56 offen lds
    s_add_u32 s56, s56, 114688
    s_cmp_eq_u32 s56, 1835008
    s_cselect_b32 s56, 0, s56
    v_mfma_f32_32x32x16_bf16 v[96:111], v[40:43], v[36:39], v[96:111]
    s_waitcnt lgkmcnt(0)
    v_mfma_f32_32x32x16_bf16 v[64:79], v[24:27], v[16:19], v[64:79]
    ds_read_b128 v[32:35], v7 offset:16384
    ds_read_b64_tr_b16 v[40:41], v8 offset:36864
    ds_read_b64_tr_b16 v[42:43], v8 offset:37888
    v_mfma_f32_32x32x16_bf16 v[80:95], v[28:31], v[16:19], v[80:95]
    ds_read_b128 v[36:39], v7 offset:20480
    ds_read_b64_tr_b16 v[44:45], v9 offset:36864
    ds_read_b64_tr_b16 v[46:47], v9 offset:37888
    v_mfma_f32_32x32x16_bf16 v[112:127], v[28:31], v[20:23], v[112:127]
    v_mfma_f32_32x32x16_bf16 v[96:111], v[24:27], v[20:23], v[96:111]
    s_waitcnt vmcnt(3) lgkmcnt(0)
    s_barrier
    v_mfma_f32_32x32x16_bf16 v[64:79], v[40:43], v[32:35], v[64:79]
    ds_read_b128 v[16:19], v4 offset:0
    ds_read_b64_tr_b16 v[24:25], v8 offset:0
    ds_read_b64_tr_b16 v[26:27], v8 offset:1024
    v_mfma_f32_32x32x16_bf16 v[80:95], v[44:47], v[32:35], v[80:95]
    ds_read_b128 v[20:23], v4 offset:4096
    ds_read_b64_tr_b16 v[28:29], v9 offset:0
    ds_read_b64_tr_b16 v[30:31], v9 offset:1024
    v_mfma_f32_32x32x16_bf16 v[112:127], v[44:47], v[36:39], v[112:127]
    s_add_u32 m0, s49, 65536
    s_nop 0
    buffer_load_dwordx4 v2, s[16:19], s56 offen lds
    s_add_u32 m0, s49, 73728
    s_nop 0
    buffer_load_dwordx4 v3, s[20:23], s56 offen lds
    s_add_u32 s56, s56, 114688
    s_cmp_eq_u32 s56, 1835008
    s_cselect_b32 s56, 0, s56
    v_mfma_f32_32x32x16_bf16 v[96:111], v[40:43], v[36:39], v[96:111]
    s_add_u32 m0, s49, 16384
    s_add_u32 s50, s55, s54
    buffer_load_dwordx4 v1, s[12:15], s50 offen lds
    s_add_u32 m0, s49, 24576
    s_add_u32 s50, s50, 0x10000
    buffer_load_dwordx4 v1, s[12:15], s50 offen lds
    s_add_u32 s54, s54, 128
    s_and_b32 s54, s54, 1023
    s_waitcnt lgkmcnt(0)
    v_mfma_f32_32x32x16_bf16 v[64:79], v[24:27], v[16:19], v[64:79]
    ds_read_b128 v[32:35], v5 offset:0
    ds_read_b64_tr_b16 v[40:41], v8 offset:4096
    ds_read_b64_tr_b16 v[42:43], v8 offset:5120
    v_mfma_f32_32x32x16_bf16 v[80:95], v[28:31], v[16:19], v[80:95]
    ds_read_b128 v[36:39], v5 offset:4096
    ds_read_b64_tr_b16 v[44:45], v9 offset:4096
    ds_read_b64_tr_b16 v[46:47], v9 offset:5120
    v_mfma_f32_32x32x16_bf16 v[112:127], v[28:31], v[20:23], v[112:127]
    v_mfma_f32_32x32x16_bf16 v[96:111], v[24:27], v[20:23], v[96:111]
    s_waitcnt vmcnt(4) lgkmcnt(0)
    s_barrier
    v_mfma_f32_32x32x16_bf16 v[64:79], v[40:43], v[32:35], v[64:79]
    ds_read_b128 v[16:19], v6 offset:0
    ds_read_b64_tr_b16 v[24:25], v8 offset:16384
    ds_read_b64_tr_b16 v[26:27], v8 offset:17408
    v_mfma_f32_32x32x16_bf16 v[80:95], v[44:47], v[32:35], v[80:95]
    ds_read_b128 v[20:23], v6 offset:4096
    ds_read_b64_tr_b16 v[28:29], v9 offset:16384
    ds_read_b64_tr_b16 v[30:31], v9 offset:17408
    v_mfma_f32_32x32x16_bf16 v[112:127], v[44:47], v[36:39], v[112:127]
    s_add_u32 m0, s49, 32768
    s_nop 0
    buffer_load_dwordx4 v2, s[16:19], s56 offen lds
    s_add_u32 m0, s49, 40960
    s_nop 0
    buffer_load_dwordx4 v3, s[20:23], s56 offen lds
    s_add_u32 s56, s56, 114688
    s_cmp_eq_u32 s56, 1835008
    s_cselect_b32 s56, 0, s56
    v_mfma_f32_32x32x16_bf16 v[96:111], v[40:43], v[36:39], v[96:111]
    s_waitcnt lgkmcnt(0)
    v_mfma_f32_32x32x16_bf16 v[64:79], v[24:27], v[16:19], v[64:79]
    ds_read_b128 v[32:35], v7 offset:0
    ds_read_b64_tr_b16 v[40:41], v8 offset:20480
    ds_read_b64_tr_b16 v[42:43], v8 offset:21504
    v_mfma_f32_32x32x16_bf16 v[80:95], v[28:31], v[16:19], v[80:95]
    ds_read_b128 v[36:39], v7 offset:4096
    ds_read_b64_tr_b16 v[44:45], v9 offset:20480
    ds_read_b64_tr_b16 v[46:47], v9 offset:21504
    v_mfma_f32_32x32x16_bf16 v[112:127], v[28:31], v[20:23], v[112:127]
    v_mfma_f32_32x32x16_bf16 v[96:111], v[24:27], v[20:23], v[96:111]
    s_waitcnt vmcnt(2) lgkmcnt(0)
    s_barrier
    v_mfma_f32_32x32x16_bf16 v[64:79], v[40:43], v[32:35], v[64:79]
    ds_read_b128 v[16:19], v4 offset:16384
    ds_read_b64_tr_b16 v[24:25], v8 offset:32768
    ds_read_b64_tr_b16 v[26:27], v8 offset:33792
    v_mfma_f32_32x32x16_bf16 v[80:95], v[44:47], v[32:35], v[80:95]
    ds_read_b128 v[20:23], v4 offset:20480
    ds_read_b64_tr_b16 v[28:29], v9 offset:32768
    ds_read_b64_tr_b16 v[30:31], v9 offset:33792
    v_mfma_f32_32x32x16_bf16 v[112:127], v[44:47], v[36:39], v[112:127]
    v_mfma_f32_32x32x16_bf16 v[96:111], v[40:43], v[36:39], v[96:111]
    s_lshl_b32 s50, s61, 3
    s_add_u32 s50, s50, s3
    s_mul_i32 s50, s50, 7168
    s_mov_b32 exec_hi, 0xffffff
    buffer_load_dword v11, v13, s[32:35], s50 offen
    s_mov_b64 exec, -1
    s_waitcnt lgkmcnt(0)
    v_mfma_f32_32x32x16_bf16 v[64:79], v[24:27], v[16:19], v[64:79]
    ds_read_b128 v[32:35], v5 offset:16384
    ds_read_b64_tr_b16 v[40:41], v8 offset:36864
    ds_read_b64_tr_b16 v[42:43], v8 offset:37888
    v_mfma_f32_32x32x16_bf16 v[80:95], v[28:31], v[16:19], v[80:95]
    ds_read_b128 v[36:39], v5 offset:20480
    ds_read_b64_tr_b16 v[44:45], v9 offset:36864
    ds_read_b64_tr_b16 v[46:47], v9 offset:37888
    v_mfma_f32_32x32x16_bf16 v[112:127], v[28:31], v[20:23], v[112:127]
    v_mfma_f32_32x32x16_bf16 v[96:111], v[24:27], v[20:23], v[96:111]
    s_waitcnt vmcnt(1) lgkmcnt(0)
    s_barrier
    v_mfma_f32_32x32x16_bf16 v[64:79], v[40:43], v[32:35], v[64:79]
    ds_read_b128 v[16:19], v6 offset:16384
    ds_read_b64_tr_b16 v[24:25], v8 offset:0
    ds_read_b64_tr_b16 v[26:27], v8 offset:1024
    v_mfma_f32_32x32x16_bf16 v[80:95], v[44:47], v[32:35], v[80:95]
    ds_read_b128 v[20:23], v6 offset:20480
    ds_read_b64_tr_b16 v[28:29], v9 offset:0
    ds_read_b64_tr_b16 v[30:31], v9 offset:1024
    v_mfma_f32_32x32x16_bf16 v[112:127], v[44:47], v[36:39], v[112:127]
    v_mfma_f32_32x32x16_bf16 v[96:111], v[40:43], v[36:39], v[96:111]
    s_waitcnt lgkmcnt(0)
    v_mfma_f32_32x32x16_bf16 v[64:79], v[24:27], v[16:19], v[64:79]
    ds_read_b128 v[32:35], v7 offset:16384
    ds_read_b64_tr_b16 v[40:41], v8 offset:4096
    ds_read_b64_tr_b16 v[42:43], v8 offset:5120
    v_mfma_f32_32x32x16_bf16 v[80:95], v[28:31], v[16:19], v[80:95]
    ds_read_b128 v[36:39], v7 offset:20480
    ds_read_b64_tr_b16 v[44:45], v9 offset:4096
    ds_read_b64_tr_b16 v[46:47], v9 offset:5120
    v_mfma_f32_32x32x16_bf16 v[112:127], v[28:31], v[20:23], v[112:127]
    v_mfma_f32_32x32x16_bf16 v[96:111], v[24:27], v[20:23], v[96:111]
    s_waitcnt lgkmcnt(0)
    v_mfma_f32_32x32x16_bf16 v[64:79], v[40:43], v[32:35], v[64:79]
    v_mfma_f32_32x32x16_bf16 v[80:95], v[44:47], v[32:35], v[80:95]
    v_mfma_f32_32x32x16_bf16 v[112:127], v[44:47], v[36:39], v[112:127]
    v_mfma_f32_32x32x16_bf16 v[96:111], v[40:43], v[36:39], v[96:111]
    s_setprio 3
    s_barrier
    s_add_u32 m0, s49, 0
    s_mov_b32 s50, 0
    buffer_load_dwordx4 v50, s[36:39], s50 offen lds
    s_add_u32 m0, s49, 8192
    s_mov_b32 s50, 65536
    buffer_load_dwordx4 v50, s[36:39], s50 offen lds
    s_add_u32 m0, s49, 16384
    s_mov_b32 s50, 131072
    buffer_load_dwordx4 v50, s[36:39], s50 offen lds
    s_add_u32 m0, s49, 24576
    s_mov_b32 s50, 196608
    buffer_load_dwordx4 v50, s[36:39], s50 offen lds
    s_add_u32 m0, s49, 32768
    s_mov_b32 s50, 262144
    buffer_load_dwordx4 v50, s[36:39], s50 offen lds
    s_add_u32 m0, s49, 40960
    s_mov_b32 s50, 327680
    buffer_load_dwordx4 v50, s[36:39], s50 offen lds
    s_add_u32 m0, s49, 49152
    s_mov_b32 s50, 393216
    buffer_load_dwordx4 v50, s[36:39], s50 offen lds
    s_add_u32 m0, s49, 57344
    s_mov_b32 s50, 458752
    buffer_load_dwordx4 v50, s[36:39], s50 offen lds
    s_mov_b32 s52, 0xbfb8aa3b
    s_mov_b32 s53, 0xbfb8aa3b
    v_pk_mul_f32 v[16:17], v[64:65], s[52:53]
    v_pk_mul_f32 v[18:19], v[66:67], s[52:53]
    v_pk_mul_f32 v[20:21], v[68:69], s[52:53]
    v_pk_mul_f32 v[22:23], v[70:71], s[52:53]
    v_exp_f32 v16, v16
    v_exp_f32 v17, v17
    v_exp_f32 v18, v18
    v_exp_f32 v19, v19
    v_exp_f32 v20, v20
    v_exp_f32 v21, v21
    v_exp_f32 v22, v22
    v_exp_f32 v23, v23
    v_pk_mul_f32 v[64:65], v[64:65], v[72:73]
    v_pk_mul_f32 v[66:67], v[66:67], v[74:75]
    v_pk_mul_f32 v[68:69], v[68:69], v[76:77]
    v_pk_mul_f32 v[70:71], v[70:71], v[78:79]
    v_pk_add_f32 v[16:17], v[16:17], v[12:13] op_sel_hi:[1,0]
    v_pk_add_f32 v[18:19], v[18:19], v[12:13] op_sel_hi:[1,0]
    v_pk_add_f32 v[20:21], v[20:21], v[12:13] op_sel_hi:[1,0]
    v_pk_add_f32 v[22:23], v[22:23], v[12:13] op_sel_hi:[1,0]
    v_rcp_f32 v16, v16
    v_rcp_f32 v17, v17
    v_rcp_f32 v18, v18
    v_rcp_f32 v19, v19
    v_rcp_f32 v20, v20
    v_rcp_f32 v21, v21
    v_rcp_f32 v22, v22
    v_rcp_f32 v23, v23
    s_nop 0
    v_pk_mul_f32 v[64:65], v[64:65], v[16:17]
    v_pk_mul_f32 v[66:67], v[66:67], v[18:19]
    v_pk_mul_f32 v[68:69], v[68:69], v[20:21]
    v_pk_mul_f32 v[70:71], v[70:71], v[22:23]
    v_cvt_pk_bf16_f32 v32, v64, v65
    v_cvt_pk_bf16_f32 v33, v66, v67
    v_cvt_pk_bf16_f32 v34, v68, v69
    v_cvt_pk_bf16_f32 v35, v70, v71
    buffer_store_dwordx4 v[32:35], v48, s[24:27], s101 offen offset:0 sc0 sc1
    v_pk_mul_f32 v[24:25], v[80:81], s[52:53]
    v_pk_mul_f32 v[26:27], v[82:83], s[52:53]
    v_pk_mul_f32 v[28:29], v[84:85], s[52:53]
    v_pk_mul_f32 v[30:31], v[86:87], s[52:53]
    v_exp_f32 v24, v24
    v_exp_f32 v25, v25
    v_exp_f32 v26, v26
    v_exp_f32 v27, v27
    v_exp_f32 v28, v28
    v_exp_f32 v29, v29
    v_exp_f32 v30, v30
    v_exp_f32 v31, v31
    v_pk_mul_f32 v[80:81], v[80:81], v[88:89]
    v_pk_mul_f32 v[82:83], v[82:83], v[90:91]
    v_pk_mul_f32 v[84:85], v[84:85], v[92:93]
    v_pk_mul_f32 v[86:87], v[86:87], v[94:95]
    v_pk_add_f32 v[24:25], v[24:25], v[12:13] op_sel_hi:[1,0]
    v_pk_add_f32 v[26:27], v[26:27], v[12:13] op_sel_hi:[1,0]
    v_pk_add_f32 v[28:29], v[28:29], v[12:13] op_sel_hi:[1,0]
    v_pk_add_f32 v[30:31], v[30:31], v[12:13] op_sel_hi:[1,0]
    v_rcp_f32 v24, v24
    v_rcp_f32 v25, v25
    v_rcp_f32 v26, v26
    v_rcp_f32 v27, v27
    v_rcp_f32 v28, v28
    v_rcp_f32 v29, v29
    v_rcp_f32 v30, v30
    v_rcp_f32 v31, v31
    s_nop 0
    v_pk_mul_f32 v[80:81], v[80:81], v[24:25]
    v_pk_mul_f32 v[82:83], v[82:83], v[26:27]
    v_pk_mul_f32 v[84:85], v[84:85], v[28:29]
    v_pk_mul_f32 v[86:87], v[86:87], v[30:31]
    v_cvt_pk_bf16_f32 v36, v80, v81
    v_cvt_pk_bf16_f32 v37, v82, v83
    v_cvt_pk_bf16_f32 v38, v84, v85
    v_cvt_pk_bf16_f32 v39, v86, v87
    buffer_store_dwordx4 v[36:39], v48, s[24:27], s101 offen offset:1024 sc0 sc1
    v_pk_mul_f32 v[16:17], v[96:97], s[52:53]
    v_pk_mul_f32 v[18:19], v[98:99], s[52:53]
    v_pk_mul_f32 v[20:21], v[100:101], s[52:53]
    v_pk_mul_f32 v[22:23], v[102:103], s[52:53]
    v_exp_f32 v16, v16
    v_exp_f32 v17, v17
    v_exp_f32 v18, v18
    v_exp_f32 v19, v19
    v_exp_f32 v20, v20
    v_exp_f32 v21, v21
    v_exp_f32 v22, v22
    v_exp_f32 v23, v23
    v_pk_mul_f32 v[96:97], v[96:97], v[104:105]
    v_pk_mul_f32 v[98:99], v[98:99], v[106:107]
    v_pk_mul_f32 v[100:101], v[100:101], v[108:109]
    v_pk_mul_f32 v[102:103], v[102:103], v[110:111]
    v_pk_add_f32 v[16:17], v[16:17], v[12:13] op_sel_hi:[1,0]
    v_pk_add_f32 v[18:19], v[18:19], v[12:13] op_sel_hi:[1,0]
    v_pk_add_f32 v[20:21], v[20:21], v[12:13] op_sel_hi:[1,0]
    v_pk_add_f32 v[22:23], v[22:23], v[12:13] op_sel_hi:[1,0]
    v_rcp_f32 v16, v16
    v_rcp_f32 v17, v17
    v_rcp_f32 v18, v18
    v_rcp_f32 v19, v19
    v_rcp_f32 v20, v20
    v_rcp_f32 v21, v21
    v_rcp_f32 v22, v22
    v_rcp_f32 v23, v23
    s_nop 0
    v_pk_mul_f32 v[96:97], v[96:97], v[16:17]
    v_pk_mul_f32 v[98:99], v[98:99], v[18:19]
    v_pk_mul_f32 v[100:101], v[100:101], v[20:21]
    v_pk_mul_f32 v[102:103], v[102:103], v[22:23]
    v_cvt_pk_bf16_f32 v40, v96, v97
    v_cvt_pk_bf16_f32 v41, v98, v99
    v_cvt_pk_bf16_f32 v42, v100, v101
    v_cvt_pk_bf16_f32 v43, v102, v103
    buffer_store_dwordx4 v[40:43], v48, s[24:27], s63 offen offset:0 sc0 sc1
    v_pk_mul_f32 v[24:25], v[112:113], s[52:53]
    v_pk_mul_f32 v[26:27], v[114:115], s[52:53]
    v_pk_mul_f32 v[28:29], v[116:117], s[52:53]
    v_pk_mul_f32 v[30:31], v[118:119], s[52:53]
    v_exp_f32 v24, v24
    v_exp_f32 v25, v25
    v_exp_f32 v26, v26
    v_exp_f32 v27, v27
    v_exp_f32 v28, v28
    v_exp_f32 v29, v29
    v_exp_f32 v30, v30
    v_exp_f32 v31, v31
    v_pk_mul_f32 v[112:113], v[112:113], v[120:121]
    v_pk_mul_f32 v[114:115], v[114:115], v[122:123]
    v_pk_mul_f32 v[116:117], v[116:117], v[124:125]
    v_pk_mul_f32 v[118:119], v[118:119], v[126:127]
    v_pk_add_f32 v[24:25], v[24:25], v[12:13] op_sel_hi:[1,0]
    v_pk_add_f32 v[26:27], v[26:27], v[12:13] op_sel_hi:[1,0]
    v_pk_add_f32 v[28:29], v[28:29], v[12:13] op_sel_hi:[1,0]
    v_pk_add_f32 v[30:31], v[30:31], v[12:13] op_sel_hi:[1,0]
    v_rcp_f32 v24, v24
    v_rcp_f32 v25, v25
    v_rcp_f32 v26, v26
    v_rcp_f32 v27, v27
    v_rcp_f32 v28, v28
    v_rcp_f32 v29, v29
    v_rcp_f32 v30, v30
    v_rcp_f32 v31, v31
    s_nop 0
    v_pk_mul_f32 v[112:113], v[112:113], v[24:25]
    v_pk_mul_f32 v[114:115], v[114:115], v[26:27]
    v_pk_mul_f32 v[116:117], v[116:117], v[28:29]
    v_pk_mul_f32 v[118:119], v[118:119], v[30:31]
    v_cvt_pk_bf16_f32 v44, v112, v113
    v_cvt_pk_bf16_f32 v45, v114, v115
    v_cvt_pk_bf16_f32 v46, v116, v117
    v_cvt_pk_bf16_f32 v47, v118, v119
    buffer_store_dwordx4 v[44:47], v48, s[24:27], s63 offen offset:1024 sc0 sc1
    s_branch F_pub
F_one:
    ds_read_b128 v[16:19], v4 offset:0
    ds_read_b64_tr_b16 v[24:25], v8 offset:0
    ds_read_b64_tr_b16 v[26:27], v8 offset:1024
    ds_read_b128 v[20:23], v4 offset:4096
    s_waitcnt lgkmcnt(0)
    v_mfma_f32_32x32x16_bf16 v[64:79], v[24:27], v[16:19], 0
    ds_read_b128 v[32:35], v5 offset:0
    ds_read_b64_tr_b16 v[40:41], v8 offset:4096
    ds_read_b64_tr_b16 v[42:43], v8 offset:5120
    v_mfma_f32_32x32x16_bf16 v[96:111], v[24:27], v[20:23], 0
    ds_read_b128 v[36:39], v5 offset:4096
    s_waitcnt vmcnt(4) lgkmcnt(0)
    s_barrier
    v_mfma_f32_32x32x16_bf16 v[64:79], v[40:43], v[32:35], v[64:79]
    ds_read_b128 v[16:19], v6 offset:0
    ds_read_b64_tr_b16 v[24:25], v8 offset:16384
    ds_read_b64_tr_b16 v[26:27], v8 offset:17408
    v_mfma_f32_32x32x16_bf16 v[96:111], v[40:43], v[36:39], v[96:111]
    ds_read_b128 v[20:23], v6 offset:4096
    s_add_u32 m0, s49, 32768
    s_nop 0
    buffer_load_dwordx4 v2, s[16:19], s56 offen lds
    s_add_u32 m0, s49, 40960
    s_nop 0
    buffer_load_dwordx4 v3, s[20:23], s56 offen lds
    s_add_u32 s56, s56, 114688
    s_cmp_eq_u32 s56, 1835008
    s_cselect_b32 s56, 0, s56
    s_waitcnt lgkmcnt(0)
    v_mfma_f32_32x32x16_bf16 v[64:79], v[24:27], v[16:19], v[64:79]
    ds_read_b128 v[32:35], v7 offset:0
    ds_read_b64_tr_b16 v[40:41], v8 offset:20480
    ds_read_b64_tr_b16 v[42:43], v8 offset:21504
    v_mfma_f32_32x32x16_bf16 v[96:111], v[24:27], v[20:23], v[96:111]
    ds_read_b128 v[36:39], v7 offset:4096
    s_waitcnt vmcnt(2) lgkmcnt(0)
    s_barrier
    v_mfma_f32_32x32x16_bf16 v[64:79], v[40:43], v[32:35], v[64:79]
    ds_read_b128 v[16:19], v4 offset:16384
    ds_read_b64_tr_b16 v[24:25], v8 offset:32768
    ds_read_b64_tr_b16 v[26:27], v8 offset:33792
    v_mfma_f32_32x32x16_bf16 v[96:111], v[40:43], v[36:39], v[96:111]
    ds_read_b128 v[20:23], v4 offset:20480
    s_add_u32 m0, s49, 49152
    s_nop 0
    buffer_load_dwordx4 v2, s[16:19], s56 offen lds
    s_add_u32 m0, s49, 57344
    s_nop 0
    buffer_load_dwordx4 v3, s[20:23], s56 offen lds
    s_add_u32 s56, s56, 114688
    s_cmp_eq_u32 s56, 1835008
    s_cselect_b32 s56, 0, s56
    s_add_u32 m0, s49, 0
    s_add_u32 s50, s55, s54
    buffer_load_dwordx4 v1, s[12:15], s50 offen lds
    s_add_u32 m0, s49, 8192
    s_add_u32 s50, s50, 0x10000
    buffer_load_dwordx4 v1, s[12:15], s50 offen lds
    s_add_u32 s54, s54, 128
    s_and_b32 s54, s54, 1023
    s_waitcnt lgkmcnt(0)
    v_mfma_f32_32x32x16_bf16 v[64:79], v[24:27], v[16:19], v[64:79]
    ds_read_b128 v[32:35], v5 offset:16384
    ds_read_b64_tr_b16 v[40:41], v8 offset:36864
    ds_read_b64_tr_b16 v[42:43], v8 offset:37888
    v_mfma_f32_32x32x16_bf16 v[96:111], v[24:27], v[20:23], v[96:111]
    ds_read_b128 v[36:39], v5 offset:20480
    s_waitcnt vmcnt(4) lgkmcnt(0)
    s_barrier
    v_mfma_f32_32x32x16_bf16 v[64:79], v[40:43], v[32:35], v[64:79]
    ds_read_b128 v[16:19], v6 offset:16384
    ds_read_b64_tr_b16 v[24:25], v8 offset:0
    ds_read_b64_tr_b16 v[26:27], v8 offset:1024
    v_mfma_f32_32x32x16_bf16 v[96:111], v[40:43], v[36:39], v[96:111]
    ds_read_b128 v[20:23], v6 offset:20480
    s_add_u32 m0, s49, 65536
    s_nop 0
    buffer_load_dwordx4 v2, s[16:19], s56 offen lds
    s_add_u32 m0, s49, 73728
    s_nop 0
    buffer_load_dwordx4 v3, s[20:23], s56 offen lds
    s_add_u32 s56, s56, 114688
    s_cmp_eq_u32 s56, 1835008
    s_cselect_b32 s56, 0, s56
    s_waitcnt lgkmcnt(0)
    v_mfma_f32_32x32x16_bf16 v[64:79], v[24:27], v[16:19], v[64:79]
    ds_read_b128 v[32:35], v7 offset:16384
    ds_read_b64_tr_b16 v[40:41], v8 offset:4096
    ds_read_b64_tr_b16 v[42:43], v8 offset:5120
    v_mfma_f32_32x32x16_bf16 v[96:111], v[24:27], v[20:23], v[96:111]
    ds_read_b128 v[36:39], v7 offset:20480
    s_waitcnt vmcnt(2) lgkmcnt(0)
    s_barrier
    v_mfma_f32_32x32x16_bf16 v[64:79], v[40:43], v[32:35], v[64:79]
    ds_read_b128 v[16:19], v4 offset:0
    ds_read_b64_tr_b16 v[24:25], v8 offset:16384
    ds_read_b64_tr_b16 v[26:27], v8 offset:17408
    v_mfma_f32_32x32x16_bf16 v[96:111], v[40:43], v[36:39], v[96:111]
    ds_read_b128 v[20:23], v4 offset:4096
    s_add_u32 m0, s49, 32768
    s_nop 0
    buffer_load_dwordx4 v2, s[16:19], s56 offen lds
    s_add_u32 m0, s49, 40960
    s_nop 0
    buffer_load_dwordx4 v3, s[20:23], s56 offen lds
    s_add_u32 s56, s56, 114688
    s_cmp_eq_u32 s56, 1835008
    s_cselect_b32 s56, 0, s56
    s_add_u32 m0, s49, 16384
    s_add_u32 s50, s55, s54
    buffer_load_dwordx4 v1, s[12:15], s50 offen lds
    s_add_u32 m0, s49, 24576
    s_add_u32 s50, s50, 0x10000
    buffer_load_dwordx4 v1, s[12:15], s50 offen lds
    s_add_u32 s54, s54, 128
    s_and_b32 s54, s54, 1023
    s_waitcnt lgkmcnt(0)
    v_mfma_f32_32x32x16_bf16 v[64:79], v[24:27], v[16:19], v[64:79]
    ds_read_b128 v[32:35], v5 offset:0
    ds_read_b64_tr_b16 v[40:41], v8 offset:20480
    ds_read_b64_tr_b16 v[42:43], v8 offset:21504
    v_mfma_f32_32x32x16_bf16 v[96:111], v[24:27], v[20:23], v[96:111]
    ds_read_b128 v[36:39], v5 offset:4096
    s_waitcnt vmcnt(4) lgkmcnt(0)
    s_barrier
    v_mfma_f32_32x32x16_bf16 v[64:79], v[40:43], v[32:35], v[64:79]
    ds_read_b128 v[16:19], v6 offset:0
    ds_read_b64_tr_b16 v[24:25], v8 offset:32768
    ds_read_b64_tr_b16 v[26:27], v8 offset:33792
    v_mfma_f32_32x32x16_bf16 v[96:111], v[40:43], v[36:39], v[96:111]
    ds_read_b128 v[20:23], v6 offset:4096
    s_add_u32 m0, s49, 49152
    s_nop 0
    buffer_load_dwordx4 v2, s[16:19], s56 offen lds
    s_add_u32 m0, s49, 57344
    s_nop 0
    buffer_load_dwordx4 v3, s[20:23], s56 offen lds
    s_add_u32 s56, s56, 114688
    s_cmp_eq_u32 s56, 1835008
    s_cselect_b32 s56, 0, s56
    s_setprio 0
    s_waitcnt lgkmcnt(0)
    v_mfma_f32_32x32x16_bf16 v[64:79], v[24:27], v[16:19], v[64:79]
    ds_read_b128 v[32:35], v7 offset:0
    ds_read_b64_tr_b16 v[40:41], v8 offset:36864
    ds_read_b64_tr_b16 v[42:43], v8 offset:37888
    v_mfma_f32_32x32x16_bf16 v[96:111], v[24:27], v[20:23], v[96:111]
    ds_read_b128 v[36:39], v7 offset:4096
    s_waitcnt vmcnt(2) lgkmcnt(0)
    s_barrier
    v_mfma_f32_32x32x16_bf16 v[64:79], v[40:43], v[32:35], v[64:79]
    ds_read_b128 v[16:19], v4 offset:16384
    ds_read_b64_tr_b16 v[24:25], v8 offset:0
    ds_read_b64_tr_b16 v[26:27], v8 offset:1024
    v_mfma_f32_32x32x16_bf16 v[96:111], v[40:43], v[36:39], v[96:111]
    ds_read_b128 v[20:23], v4 offset:20480
    s_add_u32 m0, s49, 65536
    s_nop 0
    buffer_load_dwordx4 v2, s[16:19], s56 offen lds
    s_add_u32 m0, s49, 73728
    s_nop 0
    buffer_load_dwordx4 v3, s[20:23], s56 offen lds
    s_add_u32 s56, s56, 114688
    s_cmp_eq_u32 s56, 1835008
    s_cselect_b32 s56, 0, s56
    s_add_u32 m0, s49, 0
    s_add_u32 s50, s55, s54
    buffer_load_dwordx4 v1, s[12:15], s50 offen lds
    s_add_u32 m0, s49, 8192
    s_add_u32 s50, s50, 0x10000
    buffer_load_dwordx4 v1, s[12:15], s50 offen lds
    s_add_u32 s54, s54, 128
    s_and_b32 s54, s54, 1023
    s_waitcnt lgkmcnt(0)
    v_mfma_f32_32x32x16_bf16 v[64:79], v[24:27], v[16:19], v[64:79]
    ds_read_b128 v[32:35], v5 offset:16384
    ds_read_b64_tr_b16 v[40:41], v8 offset:4096
    ds_read_b64_tr_b16 v[42:43], v8 offset:5120
    v_mfma_f32_32x32x16_bf16 v[96:111], v[24:27], v[20:23], v[96:111]
    ds_read_b128 v[36:39], v5 offset:20480
    s_waitcnt vmcnt(4) lgkmcnt(0)
    s_barrier
    v_mfma_f32_32x32x16_bf16 v[64:79], v[40:43], v[32:35], v[64:79]
    ds_read_b128 v[16:19], v6 offset:16384
    ds_read_b64_tr_b16 v[24:25], v8 offset:16384
    ds_read_b64_tr_b16 v[26:27], v8 offset:17408
    v_mfma_f32_32x32x16_bf16 v[96:111], v[40:43], v[36:39], v[96:111]
    ds_read_b128 v[20:23], v6 offset:20480
    s_add_u32 m0, s49, 32768
    s_nop 0
    buffer_load_dwordx4 v2, s[16:19], s56 offen lds
    s_add_u32 m0, s49, 40960
    s_nop 0
    buffer_load_dwordx4 v3, s[20:23], s56 offen lds
    s_add_u32 s56, s56, 114688
    s_cmp_eq_u32 s56, 1835008
    s_cselect_b32 s56, 0, s56
    s_waitcnt lgkmcnt(0)
    v_mfma_f32_32x32x16_bf16 v[64:79], v[24:27], v[16:19], v[64:79]
    ds_read_b128 v[32:35], v7 offset:16384
    ds_read_b64_tr_b16 v[40:41], v8 offset:20480
    ds_read_b64_tr_b16 v[42:43], v8 offset:21504
    v_mfma_f32_32x32x16_bf16 v[96:111], v[24:27], v[20:23], v[96:111]
    ds_read_b128 v[36:39], v7 offset:20480
    s_waitcnt vmcnt(2) lgkmcnt(0)
    s_barrier
    v_mfma_f32_32x32x16_bf16 v[64:79], v[40:43], v[32:35], v[64:79]
    ds_read_b128 v[16:19], v4 offset:0
    ds_read_b64_tr_b16 v[24:25], v8 offset:32768
    ds_read_b64_tr_b16 v[26:27], v8 offset:33792
    v_mfma_f32_32x32x16_bf16 v[96:111], v[40:43], v[36:39], v[96:111]
    ds_read_b128 v[20:23], v4 offset:4096
    s_add_u32 m0, s49, 49152
    s_nop 0
    buffer_load_dwordx4 v2, s[16:19], s56 offen lds
    s_add_u32 m0, s49, 57344
    s_nop 0
    buffer_load_dwordx4 v3, s[20:23], s56 offen lds
    s_add_u32 s56, s56, 114688
    s_cmp_eq_u32 s56, 1835008
    s_cselect_b32 s56, 0, s56
    s_add_u32 m0, s49, 16384
    s_add_u32 s50, s55, s54
    buffer_load_dwordx4 v1, s[12:15], s50 offen lds
    s_add_u32 m0, s49, 24576
    s_add_u32 s50, s50, 0x10000
    buffer_load_dwordx4 v1, s[12:15], s50 offen lds
    s_add_u32 s54, s54, 128
    s_and_b32 s54, s54, 1023
    s_waitcnt lgkmcnt(0)
    v_mfma_f32_32x32x16_bf16 v[64:79], v[24:27], v[16:19], v[64:79]
    ds_read_b128 v[32:35], v5 offset:0
    ds_read_b64_tr_b16 v[40:41], v8 offset:36864
    ds_read_b64_tr_b16 v[42:43], v8 offset:37888
    v_mfma_f32_32x32x16_bf16 v[96:111], v[24:27], v[20:23], v[96:111]
    ds_read_b128 v[36:39], v5 offset:4096
    s_waitcnt vmcnt(4) lgkmcnt(0)
    s_barrier
    v_mfma_f32_32x32x16_bf16 v[64:79], v[40:43], v[32:35], v[64:79]
    ds_read_b128 v[16:19], v6 offset:0
    ds_read_b64_tr_b16 v[24:25], v8 offset:0
    ds_read_b64_tr_b16 v[26:27], v8 offset:1024
    v_mfma_f32_32x32x16_bf16 v[96:111], v[40:43], v[36:39], v[96:111]
    ds_read_b128 v[20:23], v6 offset:4096
    s_add_u32 m0, s49, 65536
    s_nop 0
    buffer_load_dwordx4 v2, s[16:19], s56 offen lds
    s_add_u32 m0, s49, 73728
    s_nop 0
    buffer_load_dwordx4 v3, s[20:23], s56 offen lds
    s_add_u32 s56, s56, 114688
    s_cmp_eq_u32 s56, 1835008
    s_cselect_b32 s56, 0, s56
    s_waitcnt lgkmcnt(0)
    v_mfma_f32_32x32x16_bf16 v[64:79], v[24:27], v[16:19], v[64:79]
    ds_read_b128 v[32:35], v7 offset:0
    ds_read_b64_tr_b16 v[40:41], v8 offset:4096
    ds_read_b64_tr_b16 v[42:43], v8 offset:5120
    v_mfma_f32_32x32x16_bf16 v[96:111], v[24:27], v[20:23], v[96:111]
    ds_read_b128 v[36:39], v7 offset:4096
    s_waitcnt vmcnt(2) lgkmcnt(0)
    s_barrier
    v_mfma_f32_32x32x16_bf16 v[64:79], v[40:43], v[32:35], v[64:79]
    ds_read_b128 v[16:19], v4 offset:16384
    ds_read_b64_tr_b16 v[24:25], v8 offset:16384
    ds_read_b64_tr_b16 v[26:27], v8 offset:17408
    v_mfma_f32_32x32x16_bf16 v[96:111], v[40:43], v[36:39], v[96:111]
    ds_read_b128 v[20:23], v4 offset:20480
    s_add_u32 m0, s49, 32768
    s_nop 0
    buffer_load_dwordx4 v2, s[16:19], s56 offen lds
    s_add_u32 m0, s49, 40960
    s_nop 0
    buffer_load_dwordx4 v3, s[20:23], s56 offen lds
    s_add_u32 s56, s56, 114688
    s_cmp_eq_u32 s56, 1835008
    s_cselect_b32 s56, 0, s56
    s_add_u32 m0, s49, 0
    s_add_u32 s50, s55, s54
    buffer_load_dwordx4 v1, s[12:15], s50 offen lds
    s_add_u32 m0, s49, 8192
    s_add_u32 s50, s50, 0x10000
    buffer_load_dwordx4 v1, s[12:15], s50 offen lds
    s_add_u32 s54, s54, 128
    s_and_b32 s54, s54, 1023
    s_lshl_b32 s50, s61, 3
    s_add_u32 s50, s50, s3
    s_mul_i32 s50, s50, 2048
    s_mov_b64 exec, 0xffff
    buffer_load_dword v11, v13, s[36:39], s50 offen
    s_mov_b64 exec, -1
    s_waitcnt lgkmcnt(0)
    v_mfma_f32_32x32x16_bf16 v[64:79], v[24:27], v[16:19], v[64:79]
    ds_read_b128 v[32:35], v5 offset:16384
    ds_read_b64_tr_b16 v[40:41], v8 offset:20480
    ds_read_b64_tr_b16 v[42:43], v8 offset:21504
    v_mfma_f32_32x32x16_bf16 v[96:111], v[24:27], v[20:23], v[96:111]
    ds_read_b128 v[36:39], v5 offset:20480
    s_waitcnt vmcnt(5) lgkmcnt(0)
    s_barrier
    v_mfma_f32_32x32x16_bf16 v[64:79], v[40:43], v[32:35], v[64:79]
    ds_read_b128 v[16:19], v6 offset:16384
    ds_read_b64_tr_b16 v[24:25], v8 offset:32768
    ds_read_b64_tr_b16 v[26:27], v8 offset:33792
    v_mfma_f32_32x32x16_bf16 v[96:111], v[40:43], v[36:39], v[96:111]
    ds_read_b128 v[20:23], v6 offset:20480
    s_add_u32 m0, s49, 49152
    s_nop 0
    buffer_load_dwordx4 v2, s[16:19], s56 offen lds
    s_add_u32 m0, s49, 57344
    s_nop 0
    buffer_load_dwordx4 v3, s[20:23], s56 offen lds
    s_add_u32 s56, s56, 114688
    s_cmp_eq_u32 s56, 1835008
    s_cselect_b32 s56, 0, s56
    s_waitcnt lgkmcnt(0)
    v_mfma_f32_32x32x16_bf16 v[64:79], v[24:27], v[16:19], v[64:79]
    ds_read_b128 v[32:35], v7 offset:16384
    ds_read_b64_tr_b16 v[40:41], v8 offset:36864
    ds_read_b64_tr_b16 v[42:43], v8 offset:37888
    v_mfma_f32_32x32x16_bf16 v[96:111], v[24:27], v[20:23], v[96:111]
    ds_read_b128 v[36:39], v7 offset:20480
    s_waitcnt vmcnt(3) lgkmcnt(0)
    s_barrier
    v_mfma_f32_32x32x16_bf16 v[64:79], v[40:43], v[32:35], v[64:79]
    ds_read_b128 v[16:19], v4 offset:0
    ds_read_b64_tr_b16 v[24:25], v8 offset:0
    ds_read_b64_tr_b16 v[26:27], v8 offset:1024
    v_mfma_f32_32x32x16_bf16 v[96:111], v[40:43], v[36:39], v[96:111]
    ds_read_b128 v[20:23], v4 offset:4096
    s_add_u32 m0, s49, 65536
    s_nop 0
    buffer_load_dwordx4 v2, s[16:19], s56 offen lds
    s_add_u32 m0, s49, 73728
    s_nop 0
    buffer_load_dwordx4 v3, s[20:23], s56 offen lds
    s_add_u32 s56, s56, 114688
    s_cmp_eq_u32 s56, 1835008
    s_cselect_b32 s56, 0, s56
    s_add_u32 m0, s49, 16384
    s_add_u32 s50, s55, s54
    buffer_load_dwordx4 v1, s[12:15], s50 offen lds
    s_add_u32 m0, s49, 24576
    s_add_u32 s50, s50, 0x10000
    buffer_load_dwordx4 v1, s[12:15], s50 offen lds
    s_add_u32 s54, s54, 128
    s_and_b32 s54, s54, 1023
    s_waitcnt lgkmcnt(0)
    v_mfma_f32_32x32x16_bf16 v[64:79], v[24:27], v[16:19], v[64:79]
    ds_read_b128 v[32:35], v5 offset:0
    ds_read_b64_tr_b16 v[40:41], v8 offset:4096
    ds_read_b64_tr_b16 v[42:43], v8 offset:5120
    v_mfma_f32_32x32x16_bf16 v[96:111], v[24:27], v[20:23], v[96:111]
    ds_read_b128 v[36:39], v5 offset:4096
    s_waitcnt vmcnt(4) lgkmcnt(0)
    s_barrier
    v_mfma_f32_32x32x16_bf16 v[64:79], v[40:43], v[32:35], v[64:79]
    ds_read_b128 v[16:19], v6 offset:0
    ds_read_b64_tr_b16 v[24:25], v8 offset:16384
    ds_read_b64_tr_b16 v[26:27], v8 offset:17408
    v_mfma_f32_32x32x16_bf16 v[96:111], v[40:43], v[36:39], v[96:111]
    ds_read_b128 v[20:23], v6 offset:4096
    s_add_u32 m0, s49, 32768
    s_nop 0
    buffer_load_dwordx4 v2, s[16:19], s56 offen lds
    s_add_u32 m0, s49, 40960
    s_nop 0
    buffer_load_dwordx4 v3, s[20:23], s56 offen lds
    s_add_u32 s56, s56, 114688
    s_cmp_eq_u32 s56, 1835008
    s_cselect_b32 s56, 0, s56
    s_waitcnt lgkmcnt(0)
    v_mfma_f32_32x32x16_bf16 v[64:79], v[24:27], v[16:19], v[64:79]
    ds_read_b128 v[32:35], v7 offset:0
    ds_read_b64_tr_b16 v[40:41], v8 offset:20480
    ds_read_b64_tr_b16 v[42:43], v8 offset:21504
    v_mfma_f32_32x32x16_bf16 v[96:111], v[24:27], v[20:23], v[96:111]
    ds_read_b128 v[36:39], v7 offset:4096
    s_waitcnt vmcnt(2) lgkmcnt(0)
    s_barrier
    v_mfma_f32_32x32x16_bf16 v[64:79], v[40:43], v[32:35], v[64:79]
    ds_read_b128 v[16:19], v4 offset:16384
    ds_read_b64_tr_b16 v[24:25], v8 offset:32768
    ds_read_b64_tr_b16 v[26:27], v8 offset:33792
    v_mfma_f32_32x32x16_bf16 v[96:111], v[40:43], v[36:39], v[96:111]
    ds_read_b128 v[20:23], v4 offset:20480
    s_lshl_b32 s50, s61, 3
    s_add_u32 s50, s50, s3
    s_mul_i32 s50, s50, 7168
    s_mov_b32 exec_hi, 0xffffff
    buffer_load_dword v11, v13, s[32:35], s50 offen
    s_mov_b64 exec, -1
    v_lshl_add_u32 v10, v15, 10, v14
    buffer_load_dwordx4 v[80:83], v10, s[12:15], s64 offen offset:0
    buffer_load_dwordx4 v[84:87], v10, s[12:15], s64 offen offset:256
    buffer_load_dwordx4 v[88:91], v10, s[12:15], s64 offen offset:512
    buffer_load_dwordx4 v[92:95], v10, s[12:15], s64 offen offset:768
    buffer_load_dwordx4 v[112:115], v14, s[44:47], 0 offen offset:0
    buffer_load_dwordx4 v[116:119], v14, s[44:47], 0 offen offset:256
    buffer_load_dwordx4 v[120:123], v14, s[44:47], 0 offen offset:512
    buffer_load_dwordx4 v[124:127], v14, s[44:47], 0 offen offset:768
    s_waitcnt lgkmcnt(0)
    v_mfma_f32_32x32x16_bf16 v[64:79], v[24:27], v[16:19], v[64:79]
    ds_read_b128 v[32:35], v5 offset:16384
    ds_read_b64_tr_b16 v[40:41], v8 offset:36864
    ds_read_b64_tr_b16 v[42:43], v8 offset:37888
    v_mfma_f32_32x32x16_bf16 v[96:111], v[24:27], v[20:23], v[96:111]
    ds_read_b128 v[36:39], v5 offset:20480
    s_waitcnt vmcnt(9) lgkmcnt(0)
    s_barrier
    v_mfma_f32_32x32x16_bf16 v[64:79], v[40:43], v[32:35], v[64:79]
    ds_read_b128 v[16:19], v6 offset:16384
    ds_read_b64_tr_b16 v[24:25], v8 offset:0
    ds_read_b64_tr_b16 v[26:27], v8 offset:1024
    v_mfma_f32_32x32x16_bf16 v[96:111], v[40:43], v[36:39], v[96:111]
    ds_read_b128 v[20:23], v6 offset:20480
    s_waitcnt lgkmcnt(0)
    v_mfma_f32_32x32x16_bf16 v[64:79], v[24:27], v[16:19], v[64:79]
    ds_read_b128 v[32:35], v7 offset:16384
    ds_read_b64_tr_b16 v[40:41], v8 offset:4096
    ds_read_b64_tr_b16 v[42:43], v8 offset:5120
    v_mfma_f32_32x32x16_bf16 v[96:111], v[24:27], v[20:23], v[96:111]
    ds_read_b128 v[36:39], v7 offset:20480
    s_waitcnt lgkmcnt(0)
    v_mfma_f32_32x32x16_bf16 v[64:79], v[40:43], v[32:35], v[64:79]
    v_mfma_f32_32x32x16_bf16 v[96:111], v[40:43], v[36:39], v[96:111]
    s_setprio 3
    s_barrier
    s_add_u32 m0, s49, 0
    s_mov_b32 s50, 0
    buffer_load_dwordx4 v50, s[36:39], s50 offen lds
    s_add_u32 m0, s49, 8192
    s_mov_b32 s50, 65536
    buffer_load_dwordx4 v50, s[36:39], s50 offen lds
    s_add_u32 m0, s49, 16384
    s_mov_b32 s50, 131072
    buffer_load_dwordx4 v50, s[36:39], s50 offen lds
    s_add_u32 m0, s49, 24576
    s_mov_b32 s50, 196608
    buffer_load_dwordx4 v50, s[36:39], s50 offen lds
    s_add_u32 m0, s49, 32768
    s_mov_b32 s50, 262144
    buffer_load_dwordx4 v50, s[36:39], s50 offen lds
    s_add_u32 m0, s49, 40960
    s_mov_b32 s50, 327680
    buffer_load_dwordx4 v50, s[36:39], s50 offen lds
    s_add_u32 m0, s49, 49152
    s_mov_b32 s50, 393216
    buffer_load_dwordx4 v50, s[36:39], s50 offen lds
    s_add_u32 m0, s49, 57344
    s_mov_b32 s50, 458752
    buffer_load_dwordx4 v50, s[36:39], s50 offen lds
    s_mov_b32 s52, 0xbfb8aa3b
    s_mov_b32 s53, 0xbfb8aa3b
    v_pk_mul_f32 v[16:17], v[64:65], s[52:53]
    v_pk_mul_f32 v[18:19], v[66:67], s[52:53]
    v_pk_mul_f32 v[20:21], v[68:69], s[52:53]
    v_pk_mul_f32 v[22:23], v[70:71], s[52:53]
    v_exp_f32 v16, v16
    v_exp_f32 v17, v17
    v_exp_f32 v18, v18
    v_exp_f32 v19, v19
    v_exp_f32 v20, v20
    v_exp_f32 v21, v21
    v_exp_f32 v22, v22
    v_exp_f32 v23, v23
    v_pk_mul_f32 v[64:65], v[64:65], v[72:73]
    v_pk_mul_f32 v[66:67], v[66:67], v[74:75]
    v_pk_mul_f32 v[68:69], v[68:69], v[76:77]
    v_pk_mul_f32 v[70:71], v[70:71], v[78:79]
    v_pk_add_f32 v[16:17], v[16:17], v[12:13] op_sel_hi:[1,0]
    v_pk_add_f32 v[18:19], v[18:19], v[12:13] op_sel_hi:[1,0]
    v_pk_add_f32 v[20:21], v[20:21], v[12:13] op_sel_hi:[1,0]
    v_pk_add_f32 v[22:23], v[22:23], v[12:13] op_sel_hi:[1,0]
    v_rcp_f32 v16, v16
    v_rcp_f32 v17, v17
    v_rcp_f32 v18, v18
    v_rcp_f32 v19, v19
    v_rcp_f32 v20, v20
    v_rcp_f32 v21, v21
    v_rcp_f32 v22, v22
    v_rcp_f32 v23, v23
    s_nop 0
    v_pk_mul_f32 v[64:65], v[64:65], v[16:17]
    v_pk_mul_f32 v[66:67], v[66:67], v[18:19]
    v_pk_mul_f32 v[68:69], v[68:69], v[20:21]
    v_pk_mul_f32 v[70:71], v[70:71], v[22:23]
    v_cvt_pk_bf16_f32 v32, v64, v65
    v_cvt_pk_bf16_f32 v33, v66, v67
    v_cvt_pk_bf16_f32 v34, v68, v69
    v_cvt_pk_bf16_f32 v35, v70, v71
    buffer_store_dwordx4 v[32:35], v48, s[24:27], s101 offen offset:0 sc0 sc1
    v_pk_mul_f32 v[16:17], v[96:97], s[52:53]
    v_pk_mul_f32 v[18:19], v[98:99], s[52:53]
    v_pk_mul_f32 v[20:21], v[100:101], s[52:53]
    v_pk_mul_f32 v[22:23], v[102:103], s[52:53]
    v_exp_f32 v16, v16
    v_exp_f32 v17, v17
    v_exp_f32 v18, v18
    v_exp_f32 v19, v19
    v_exp_f32 v20, v20
    v_exp_f32 v21, v21
    v_exp_f32 v22, v22
    v_exp_f32 v23, v23
    v_pk_mul_f32 v[96:97], v[96:97], v[104:105]
    v_pk_mul_f32 v[98:99], v[98:99], v[106:107]
    v_pk_mul_f32 v[100:101], v[100:101], v[108:109]
    v_pk_mul_f32 v[102:103], v[102:103], v[110:111]
    v_pk_add_f32 v[16:17], v[16:17], v[12:13] op_sel_hi:[1,0]
    v_pk_add_f32 v[18:19], v[18:19], v[12:13] op_sel_hi:[1,0]
    v_pk_add_f32 v[20:21], v[20:21], v[12:13] op_sel_hi:[1,0]
    v_pk_add_f32 v[22:23], v[22:23], v[12:13] op_sel_hi:[1,0]
    v_rcp_f32 v16, v16
    v_rcp_f32 v17, v17
    v_rcp_f32 v18, v18
    v_rcp_f32 v19, v19
    v_rcp_f32 v20, v20
    v_rcp_f32 v21, v21
    v_rcp_f32 v22, v22
    v_rcp_f32 v23, v23
    s_nop 0
    v_pk_mul_f32 v[96:97], v[96:97], v[16:17]
    v_pk_mul_f32 v[98:99], v[98:99], v[18:19]
    v_pk_mul_f32 v[100:101], v[100:101], v[20:21]
    v_pk_mul_f32 v[102:103], v[102:103], v[22:23]
    v_cvt_pk_bf16_f32 v40, v96, v97
    v_cvt_pk_bf16_f32 v41, v98, v99
    v_cvt_pk_bf16_f32 v42, v100, v101
    v_cvt_pk_bf16_f32 v43, v102, v103
    buffer_store_dwordx4 v[40:43], v48, s[24:27], s63 offen offset:0 sc0 sc1
    v_mov_b32 v12, 0
    v_mov_b32 v13, 0
    s_waitcnt vmcnt(10)
    v_dot2_f32_bf16 v12, v80, v112, v12
    v_dot2_f32_bf16 v13, v81, v113, v13
    v_dot2_f32_bf16 v12, v82, v114, v12
    v_dot2_f32_bf16 v13, v83, v115, v13
    v_dot2_f32_bf16 v12, v84, v116, v12
    v_dot2_f32_bf16 v13, v85, v117, v13
    v_dot2_f32_bf16 v12, v86, v118, v12
    v_dot2_f32_bf16 v13, v87, v119, v13
    v_dot2_f32_bf16 v12, v88, v120, v12
    v_dot2_f32_bf16 v13, v89, v121, v13
    v_dot2_f32_bf16 v12, v90, v122, v12
    v_dot2_f32_bf16 v13, v91, v123, v13
    v_dot2_f32_bf16 v12, v92, v124, v12
    v_dot2_f32_bf16 v13, v93, v125, v13
    v_dot2_f32_bf16 v12, v94, v126, v12
    v_dot2_f32_bf16 v13, v95, v127, v13
    s_nop 2
    v_add_f32 v12, v12, v13
    s_nop 1
    v_add_f32_dpp v12, v12, v12 quad_perm:[1,0,3,2] row_mask:0xf bank_mask:0xf
    s_nop 1
    v_add_f32_dpp v12, v12, v12 quad_perm:[2,3,0,1] row_mask:0xf bank_mask:0xf
    s_nop 1
    v_add_f32_dpp v12, v12, v12 row_half_mirror row_mask:0xf bank_mask:0xf
    s_nop 1
    v_add_f32_dpp v12, v12, v12 row_mirror row_mask:0xf bank_mask:0xf
    v_mul_f32 v12, 0xbfb8aa3b, v12
    v_exp_f32 v12, v12
    s_lshr_b32 s50, s64, 8
    v_add_f32 v12, 1.0, v12
    v_rcp_f32 v12, v12
    v_lshlrev_b32 v11, 2, v15
    s_add_u32 s50, s50, 0xf04000
    s_mov_b32 exec_lo, 0x10001
    s_mov_b32 exec_hi, 0x10001
    buffer_store_dword v12, v11, s[24:27], s50 offen sc0 sc1
    s_mov_b64 exec, -1
F_pub:
    s_waitcnt vmcnt(0)
F_pub2:
    s_barrier
    s_cmp_lg_u32 s3, 0
    s_cbranch_scc1 F_wait2
    s_mov_b64 exec, 1
    v_mov_b32 v10, 0
    v_mov_b32 v11, s48
    buffer_store_dword v11, v10, s[24:27], s62 offen sc0 sc1
    s_mov_b64 exec, -1
    s_nop 0
F_wait2:
    ds_read_b64_tr_b16 v[0:1], v55 offset:0
    ds_read_b64_tr_b16 v[2:3], v55 offset:1024
    ds_read_b64_tr_b16 v[4:5], v55 offset:2048
    ds_read_b64_tr_b16 v[6:7], v55 offset:3072
    ds_read_b64_tr_b16 v[8:9], v55 offset:4096
    ds_read_b64_tr_b16 v[10:11], v55 offset:5120
    ds_read_b64_tr_b16 v[12:13], v55 offset:6144
    ds_read_b64_tr_b16 v[14:15], v55 offset:7168
    ds_read_b64_tr_b16 v[80:81], v55 offset:8192
    ds_read_b64_tr_b16 v[82:83], v55 offset:9216
    ds_read_b64_tr_b16 v[84:85], v55 offset:10240
    ds_read_b64_tr_b16 v[86:87], v55 offset:11264
    ds_read_b64_tr_b16 v[88:89], v55 offset:12288
    ds_read_b64_tr_b16 v[90:91], v55 offset:13312
    ds_read_b64_tr_b16 v[92:93], v55 offset:14336
    ds_read_b64_tr_b16 v[94:95], v55 offset:15360
    ds_read_b64_tr_b16 v[96:97], v55 offset:16384
    ds_read_b64_tr_b16 v[98:99], v55 offset:17408
    ds_read_b64_tr_b16 v[100:101], v55 offset:18432
    ds_read_b64_tr_b16 v[102:103], v55 offset:19456
    ds_read_b64_tr_b16 v[104:105], v55 offset:20480
    ds_read_b64_tr_b16 v[106:107], v55 offset:21504
    ds_read_b64_tr_b16 v[108:109], v55 offset:22528
    ds_read_b64_tr_b16 v[110:111], v55 offset:23552
    ds_read_b64_tr_b16 v[112:113], v55 offset:24576
    ds_read_b64_tr_b16 v[114:115], v55 offset:25600
    ds_read_b64_tr_b16 v[116:117], v55 offset:26624
    ds_read_b64_tr_b16 v[118:119], v55 offset:27648
    ds_read_b64_tr_b16 v[120:121], v55 offset:28672
    ds_read_b64_tr_b16 v[122:123], v55 offset:29696
    ds_read_b64_tr_b16 v[124:125], v55 offset:30720
    ds_read_b64_tr_b16 v[126:127], v55 offset:31744
    s_waitcnt lgkmcnt(0)
    s_barrier
    s_add_u32 m0, s49, 8192
    s_mov_b32 s50, 0
    buffer_load_dwordx4 v50, s[32:35], s50 offen lds
    s_add_u32 m0, s49, 24576
    s_mov_b32 s50, 65536
    buffer_load_dwordx4 v50, s[32:35], s50 offen lds
    s_add_u32 m0, s49, 40960
    s_mov_b32 s50, 131072
    buffer_load_dwordx4 v50, s[32:35], s50 offen lds
    s_add_u32 m0, s49, 57344
    s_mov_b32 s50, 196608
    buffer_load_dwordx4 v50, s[32:35], s50 offen lds
    s_add_u32 m0, s49, 73728
    s_mov_b32 s50, 262144
    buffer_load_dwordx4 v50, s[32:35], s50 offen lds
    s_cmp_lg_u32 s3, 0
    s_cbranch_scc1 F_wait2b
    s_mov_b32 s66, 0x40000
F_pollh:
    buffer_load_dword v16, v62, s[24:27], s99 offen sc1
    s_waitcnt vmcnt(0)
    v_cmp_ne_u32 vcc, s48, v16
    s_nop 4
    s_cmp_eq_u64 vcc, 0
    s_cbranch_scc1 F_pollh_ok
    s_sleep 2
    s_sub_u32 s66, s66, 1
    s_cmp_lg_u32 s66, 0
    s_cbranch_scc1 F_pollh
F_pollh_ok:
F_wait2b:
    s_barrier
    s_add_u32 m0, s9, 0
    s_add_u32 s50, s10, 0
    buffer_load_dwordx4 v49, s[24:27], s50 offen sc1 lds
    s_add_u32 m0, s9, 16384
    s_add_u32 s50, s10, 4096
    buffer_load_dwordx4 v49, s[24:27], s50 offen sc1 lds
    s_mov_b64 exec, 0x3fff3fff
    buffer_load_dword v56, v56, s[24:27], s11 offen sc1
    s_mov_b64 exec, -1
    buffer_load_dword v57, v57, s[24:27], s67 offen sc1
    s_add_u32 m0, s9, 32768
    s_add_u32 s50, s10, 8192
    buffer_load_dwordx4 v49, s[24:27], s50 offen sc1 lds
    s_add_u32 m0, s9, 49152
    s_add_u32 s50, s10, 12288
    buffer_load_dwordx4 v49, s[24:27], s50 offen sc1 lds
    s_add_u32 m0, s9, 65536
    s_add_u32 s50, s10, 16384
    buffer_load_dwordx4 v49, s[24:27], s50 offen sc1 lds
    s_setprio 0
    s_waitcnt vmcnt(5)
    s_barrier
    ds_read_b128 v[16:19], v51 offset:0
    ds_read_b64_tr_b16 v[24:25], v52 offset:0
    ds_read_b64_tr_b16 v[26:27], v52 offset:1024
    ds_read_b128 v[20:23], v51 offset:1024
    ds_read_b64_tr_b16 v[28:29], v52 offset:2048
    ds_read_b64_tr_b16 v[30:31], v52 offset:3072
    s_waitcnt lgkmcnt(0)
    v_mfma_f32_32x32x16_bf16 v[64:79], v[24:27], v[16:19], 0
    ds_read_b128 v[32:35], v51 offset:16384
    ds_read_b64_tr_b16 v[40:41], v52 offset:16384
    ds_read_b64_tr_b16 v[42:43], v52 offset:17408
    v_mfma_f32_32x32x16_bf16 v[64:79], v[28:31], v[20:23], v[64:79]
    ds_read_b128 v[36:39], v51 offset:17408
    ds_read_b64_tr_b16 v[44:45], v52 offset:18432
    ds_read_b64_tr_b16 v[46:47], v52 offset:19456
    s_waitcnt vmcnt(1) lgkmcnt(0)
    s_barrier
    v_mfma_f32_32x32x16_bf16 v[64:79], v[40:43], v[32:35], v[64:79]
    ds_read_b128 v[16:19], v51 offset:32768
    ds_read_b64_tr_b16 v[24:25], v52 offset:32768
    ds_read_b64_tr_b16 v[26:27], v52 offset:33792
    v_mfma_f32_32x32x16_bf16 v[64:79], v[44:47], v[36:39], v[64:79]
    ds_read_b128 v[20:23], v51 offset:33792
    ds_read_b64_tr_b16 v[28:29], v52 offset:34816
    ds_read_b64_tr_b16 v[30:31], v52 offset:35840
    s_add_u32 m0, s9, 0
    s_add_u32 s50, s10, 20480
    buffer_load_dwordx4 v49, s[24:27], s50 offen sc1 lds
    s_add_u32 m0, s49, 8192
    s_mov_b32 s50, 327680
    buffer_load_dwordx4 v50, s[32:35], s50 offen lds
    s_add_u32 m0, s9, 16384
    s_add_u32 s50, s10, 24576
    buffer_load_dwordx4 v49, s[24:27], s50 offen sc1 lds
    s_add_u32 m0, s49, 24576
    s_mov_b32 s50, 393216
    buffer_load_dwordx4 v50, s[32:35], s50 offen lds
    s_waitcnt lgkmcnt(0)
    v_mfma_f32_32x32x16_bf16 v[64:79], v[24:27], v[16:19], v[64:79]
    ds_read_b128 v[32:35], v51 offset:49152
    ds_read_b64_tr_b16 v[40:41], v52 offset:49152
    ds_read_b64_tr_b16 v[42:43], v52 offset:50176
    v_mfma_f32_32x32x16_bf16 v[64:79], v[28:31], v[20:23], v[64:79]
    ds_read_b128 v[36:39], v51 offset:50176
    ds_read_b64_tr_b16 v[44:45], v52 offset:51200
    ds_read_b64_tr_b16 v[46:47], v52 offset:52224
    s_waitcnt vmcnt(2) lgkmcnt(0)
    s_barrier
    v_mfma_f32_32x32x16_bf16 v[64:79], v[40:43], v[32:35], v[64:79]
    ds_read_b128 v[16:19], v53 offset:0
    ds_read_b64_tr_b16 v[24:25], v54 offset:0
    ds_read_b64_tr_b16 v[26:27], v54 offset:1024
    v_mfma_f32_32x32x16_bf16 v[64:79], v[44:47], v[36:39], v[64:79]
    ds_read_b128 v[20:23], v53 offset:1024
    ds_read_b64_tr_b16 v[28:29], v54 offset:2048
    ds_read_b64_tr_b16 v[30:31], v54 offset:3072
    s_add_u32 m0, s9, 32768
    s_add_u32 s50, s10, 28672
    buffer_load_dwordx4 v49, s[24:27], s50 offen sc1 lds
    s_add_u32 m0, s49, 40960
    s_mov_b32 s50, 458752
    buffer_load_dwordx4 v50, s[32:35], s50 offen lds
    s_add_u32 m0, s9, 49152
    s_add_u32 s50, s10, 32768
    buffer_load_dwordx4 v49, s[24:27], s50 offen sc1 lds
    s_add_u32 m0, s49, 57344
    s_mov_b32 s50, 524288
    buffer_load_dwordx4 v50, s[32:35], s50 offen lds
    s_waitcnt lgkmcnt(0)
    v_mfma_f32_32x32x16_bf16 v[64:79], v[24:27], v[16:19], v[64:79]
    ds_read_b128 v[32:35], v51 offset:0
    ds_read_b64_tr_b16 v[40:41], v52 offset:0
    ds_read_b64_tr_b16 v[42:43], v52 offset:1024
    v_mfma_f32_32x32x16_bf16 v[64:79], v[28:31], v[20:23], v[64:79]
    ds_read_b128 v[36:39], v51 offset:1024
    ds_read_b64_tr_b16 v[44:45], v52 offset:2048
    ds_read_b64_tr_b16 v[46:47], v52 offset:3072
    s_waitcnt vmcnt(2) lgkmcnt(0)
    s_barrier
    v_mfma_f32_32x32x16_bf16 v[64:79], v[40:43], v[32:35], v[64:79]
    ds_read_b128 v[16:19], v51 offset:16384
    ds_read_b64_tr_b16 v[24:25], v52 offset:16384
    ds_read_b64_tr_b16 v[26:27], v52 offset:17408
    v_mfma_f32_32x32x16_bf16 v[64:79], v[44:47], v[36:39], v[64:79]
    ds_read_b128 v[20:23], v51 offset:17408
    ds_read_b64_tr_b16 v[28:29], v52 offset:18432
    ds_read_b64_tr_b16 v[30:31], v52 offset:19456
    s_add_u32 m0, s9, 65536
    s_add_u32 s50, s10, 36864
    buffer_load_dwordx4 v49, s[24:27], s50 offen sc1 lds
    s_add_u32 m0, s49, 73728
    s_mov_b32 s50, 589824
    buffer_load_dwordx4 v50, s[32:35], s50 offen lds
    s_add_u32 m0, s9, 0
    s_add_u32 s50, s10, 40960
    buffer_load_dwordx4 v49, s[24:27], s50 offen sc1 lds
    s_add_u32 m0, s49, 8192
    s_mov_b32 s50, 655360
    buffer_load_dwordx4 v50, s[32:35], s50 offen lds
    s_waitcnt lgkmcnt(0)
    v_mfma_f32_32x32x16_bf16 v[64:79], v[24:27], v[16:19], v[64:79]
    ds_read_b128 v[32:35], v51 offset:32768
    ds_read_b64_tr_b16 v[40:41], v52 offset:32768
    ds_read_b64_tr_b16 v[42:43], v52 offset:33792
    v_mfma_f32_32x32x16_bf16 v[64:79], v[28:31], v[20:23], v[64:79]
    ds_read_b128 v[36:39], v51 offset:33792
    ds_read_b64_tr_b16 v[44:45], v52 offset:34816
    ds_read_b64_tr_b16 v[46:47], v52 offset:35840
    s_waitcnt vmcnt(2) lgkmcnt(0)
    s_barrier
    v_mfma_f32_32x32x16_bf16 v[64:79], v[40:43], v[32:35], v[64:79]
    ds_read_b128 v[16:19], v51 offset:49152
    ds_read_b64_tr_b16 v[24:25], v52 offset:49152
    ds_read_b64_tr_b16 v[26:27], v52 offset:50176
    v_mfma_f32_32x32x16_bf16 v[64:79], v[44:47], v[36:39], v[64:79]
    ds_read_b128 v[20:23], v51 offset:50176
    ds_read_b64_tr_b16 v[28:29], v52 offset:51200
    ds_read_b64_tr_b16 v[30:31], v52 offset:52224
    s_add_u32 m0, s9, 16384
    s_add_u32 s50, s10, 45056
    buffer_load_dwordx4 v49, s[24:27], s50 offen sc1 lds
    s_add_u32 m0, s49, 24576
    s_mov_b32 s50, 720896
    buffer_load_dwordx4 v50, s[32:35], s50 offen lds
    s_add_u32 m0, s9, 32768
    s_add_u32 s50, s10, 49152
    buffer_load_dwordx4 v49, s[24:27], s50 offen sc1 lds
    s_add_u32 m0, s49, 40960
    s_mov_b32 s50, 786432
    buffer_load_dwordx4 v50, s[32:35], s50 offen lds
    s_waitcnt lgkmcnt(0)
    v_mfma_f32_32x32x16_bf16 v[64:79], v[24:27], v[16:19], v[64:79]
    ds_read_b128 v[32:35], v53 offset:0
    ds_read_b64_tr_b16 v[40:41], v54 offset:0
    ds_read_b64_tr_b16 v[42:43], v54 offset:1024
    v_mfma_f32_32x32x16_bf16 v[64:79], v[28:31], v[20:23], v[64:79]
    ds_read_b128 v[36:39], v53 offset:1024
    ds_read_b64_tr_b16 v[44:45], v54 offset:2048
    ds_read_b64_tr_b16 v[46:47], v54 offset:3072
    s_waitcnt vmcnt(2) lgkmcnt(0)
    s_barrier
    v_mfma_f32_32x32x16_bf16 v[64:79], v[40:43], v[32:35], v[64:79]
    ds_read_b128 v[16:19], v51 offset:0
    ds_read_b64_tr_b16 v[24:25], v52 offset:0
    ds_read_b64_tr_b16 v[26:27], v52 offset:1024
    v_mfma_f32_32x32x16_bf16 v[64:79], v[44:47], v[36:39], v[64:79]
    ds_read_b128 v[20:23], v51 offset:1024
    ds_read_b64_tr_b16 v[28:29], v52 offset:2048
    ds_read_b64_tr_b16 v[30:31], v52 offset:3072
    s_add_u32 m0, s9, 49152
    s_add_u32 s50, s10, 53248
    buffer_load_dwordx4 v49, s[24:27], s50 offen sc1 lds
    s_add_u32 m0, s49, 57344
    s_mov_b32 s50, 851968
    buffer_load_dwordx4 v50, s[32:35], s50 offen lds
    s_add_u32 m0, s9, 65536
    s_add_u32 s50, s10, 57344
    buffer_load_dwordx4 v49, s[24:27], s50 offen sc1 lds
    s_add_u32 m0, s49, 73728
    s_mov_b32 s50, 917504
    buffer_load_dwordx4 v50, s[32:35], s50 offen lds
    s_waitcnt lgkmcnt(0)
    v_mfma_f32_32x32x16_bf16 v[64:79], v[24:27], v[16:19], v[64:79]
    ds_read_b128 v[32:35], v51 offset:16384
    ds_read_b64_tr_b16 v[40:41], v52 offset:16384
    ds_read_b64_tr_b16 v[42:43], v52 offset:17408
    v_mfma_f32_32x32x16_bf16 v[64:79], v[28:31], v[20:23], v[64:79]
    ds_read_b128 v[36:39], v51 offset:17408
    ds_read_b64_tr_b16 v[44:45], v52 offset:18432
    ds_read_b64_tr_b16 v[46:47], v52 offset:19456
    s_waitcnt vmcnt(2) lgkmcnt(0)
    s_barrier
    v_mfma_f32_32x32x16_bf16 v[64:79], v[40:43], v[32:35], v[64:79]
    ds_read_b128 v[16:19], v51 offset:32768
    ds_read_b64_tr_b16 v[24:25], v52 offset:32768
    ds_read_b64_tr_b16 v[26:27], v52 offset:33792
    v_mfma_f32_32x32x16_bf16 v[64:79], v[44:47], v[36:39], v[64:79]
    ds_read_b128 v[20:23], v51 offset:33792
    ds_read_b64_tr_b16 v[28:29], v52 offset:34816
    ds_read_b64_tr_b16 v[30:31], v52 offset:35840
    s_add_u32 m0, s9, 0
    s_add_u32 s50, s10, 61440
    buffer_load_dwordx4 v49, s[24:27], s50 offen sc1 lds
    s_add_u32 m0, s49, 8192
    s_mov_b32 s50, 983040
    buffer_load_dwordx4 v50, s[32:35], s50 offen lds
    s_add_u32 m0, s9, 16384
    s_add_u32 s50, s10, 65536
    buffer_load_dwordx4 v49, s[24:27], s50 offen sc1 lds
    s_add_u32 m0, s49, 24576
    s_mov_b32 s50, 1048576
    buffer_load_dwordx4 v50, s[32:35], s50 offen lds
    s_waitcnt lgkmcnt(0)
    v_mfma_f32_32x32x16_bf16 v[64:79], v[24:27], v[16:19], v[64:79]
    ds_read_b128 v[32:35], v51 offset:49152
    ds_read_b64_tr_b16 v[40:41], v52 offset:49152
    ds_read_b64_tr_b16 v[42:43], v52 offset:50176
    v_mfma_f32_32x32x16_bf16 v[64:79], v[28:31], v[20:23], v[64:79]
    ds_read_b128 v[36:39], v51 offset:50176
    ds_read_b64_tr_b16 v[44:45], v52 offset:51200
    ds_read_b64_tr_b16 v[46:47], v52 offset:52224
    s_waitcnt vmcnt(2) lgkmcnt(0)
    s_barrier
    v_mfma_f32_32x32x16_bf16 v[64:79], v[40:43], v[32:35], v[64:79]
    ds_read_b128 v[16:19], v53 offset:0
    ds_read_b64_tr_b16 v[24:25], v54 offset:0
    ds_read_b64_tr_b16 v[26:27], v54 offset:1024
    v_mfma_f32_32x32x16_bf16 v[64:79], v[44:47], v[36:39], v[64:79]
    ds_read_b128 v[20:23], v53 offset:1024
    ds_read_b64_tr_b16 v[28:29], v54 offset:2048
    ds_read_b64_tr_b16 v[30:31], v54 offset:3072
    s_add_u32 m0, s9, 32768
    s_add_u32 s50, s10, 69632
    buffer_load_dwordx4 v49, s[24:27], s50 offen sc1 lds
    s_add_u32 m0, s49, 40960
    s_mov_b32 s50, 1114112
    buffer_load_dwordx4 v50, s[32:35], s50 offen lds
    s_add_u32 m0, s9, 49152
    s_add_u32 s50, s10, 73728
    buffer_load_dwordx4 v49, s[24:27], s50 offen sc1 lds
    s_add_u32 m0, s49, 57344
    s_mov_b32 s50, 1179648
    buffer_load_dwordx4 v50, s[32:35], s50 offen lds
    s_waitcnt lgkmcnt(0)
    v_mfma_f32_32x32x16_bf16 v[64:79], v[24:27], v[16:19], v[64:79]
    ds_read_b128 v[32:35], v51 offset:0
    ds_read_b64_tr_b16 v[40:41], v52 offset:0
    ds_read_b64_tr_b16 v[42:43], v52 offset:1024
    v_mfma_f32_32x32x16_bf16 v[64:79], v[28:31], v[20:23], v[64:79]
    ds_read_b128 v[36:39], v51 offset:1024
    ds_read_b64_tr_b16 v[44:45], v52 offset:2048
    ds_read_b64_tr_b16 v[46:47], v52 offset:3072
    s_waitcnt vmcnt(4) lgkmcnt(0)
    s_barrier
    v_mfma_f32_32x32x16_bf16 v[64:79], v[40:43], v[32:35], v[64:79]
    ds_read_b128 v[16:19], v51 offset:16384
    ds_read_b64_tr_b16 v[24:25], v52 offset:16384
    ds_read_b64_tr_b16 v[26:27], v52 offset:17408
    v_mfma_f32_32x32x16_bf16 v[64:79], v[44:47], v[36:39], v[64:79]
    ds_read_b128 v[20:23], v51 offset:17408
    ds_read_b64_tr_b16 v[28:29], v52 offset:18432
    ds_read_b64_tr_b16 v[30:31], v52 offset:19456
    s_add_u32 m0, s9, 65536
    s_add_u32 s50, s10, 77824
    buffer_load_dwordx4 v49, s[24:27], s50 offen sc1 lds
    s_add_u32 m0, s49, 73728
    s_mov_b32 s50, 1245184
    buffer_load_dwordx4 v50, s[32:35], s50 offen lds
    s_add_u32 m0, s9, 0
    s_add_u32 s50, s10, 81920
    buffer_load_dwordx4 v49, s[24:27], s50 offen sc1 lds
    s_add_u32 m0, s49, 8192
    s_mov_b32 s50, 1310720
    buffer_load_dwordx4 v50, s[32:35], s50 offen lds
    s_waitcnt vmcnt(6) lgkmcnt(0)
    s_barrier
    v_mfma_f32_32x32x16_bf16 v[64:79], v[24:27], v[16:19], v[64:79]
    ds_read_b128 v[32:35], v51 offset:32768
    ds_read_b64_tr_b16 v[40:41], v52 offset:32768
    ds_read_b64_tr_b16 v[42:43], v52 offset:33792
    v_mfma_f32_32x32x16_bf16 v[64:79], v[28:31], v[20:23], v[64:79]
    ds_read_b128 v[36:39], v51 offset:33792
    ds_read_b64_tr_b16 v[44:45], v52 offset:34816
    ds_read_b64_tr_b16 v[46:47], v52 offset:35840
    s_add_u32 m0, s9, 16384
    s_add_u32 s50, s10, 86016
    buffer_load_dwordx4 v49, s[24:27], s50 offen sc1 lds
    s_add_u32 m0, s49, 24576
    s_mov_b32 s50, 1376256
    buffer_load_dwordx4 v50, s[32:35], s50 offen lds
    s_waitcnt vmcnt(6) lgkmcnt(0)
    s_barrier
    v_mfma_f32_32x32x16_bf16 v[64:79], v[40:43], v[32:35], v[64:79]
    ds_read_b128 v[16:19], v51 offset:49152
    ds_read_b64_tr_b16 v[24:25], v52 offset:49152
    ds_read_b64_tr_b16 v[26:27], v52 offset:50176
    v_mfma_f32_32x32x16_bf16 v[64:79], v[44:47], v[36:39], v[64:79]
    ds_read_b128 v[20:23], v51 offset:50176
    ds_read_b64_tr_b16 v[28:29], v52 offset:51200
    ds_read_b64_tr_b16 v[30:31], v52 offset:52224
    s_add_u32 m0, s9, 32768
    s_add_u32 s50, s10, 90112
    buffer_load_dwordx4 v49, s[24:27], s50 offen sc1 lds
    s_add_u32 m0, s49, 40960
    s_mov_b32 s50, 1441792
    buffer_load_dwordx4 v50, s[32:35], s50 offen lds
    s_waitcnt vmcnt(6) lgkmcnt(0)
    s_barrier
    v_mfma_f32_32x32x16_bf16 v[64:79], v[24:27], v[16:19], v[64:79]
    ds_read_b128 v[32:35], v53 offset:0
    ds_read_b64_tr_b16 v[40:41], v54 offset:0
    ds_read_b64_tr_b16 v[42:43], v54 offset:1024
    v_mfma_f32_32x32x16_bf16 v[64:79], v[28:31], v[20:23], v[64:79]
    ds_read_b128 v[36:39], v53 offset:1024
    ds_read_b64_tr_b16 v[44:45], v54 offset:2048
    ds_read_b64_tr_b16 v[46:47], v54 offset:3072
    s_add_u32 m0, s9, 49152
    s_add_u32 s50, s10, 94208
    buffer_load_dwordx4 v49, s[24:27], s50 offen sc1 lds
    s_add_u32 m0, s49, 57344
    s_mov_b32 s50, 1507328
    buffer_load_dwordx4 v50, s[32:35], s50 offen lds
    s_waitcnt vmcnt(6) lgkmcnt(0)
    s_barrier
    v_mfma_f32_32x32x16_bf16 v[64:79], v[40:43], v[32:35], v[64:79]
    ds_read_b128 v[16:19], v51 offset:0
    ds_read_b64_tr_b16 v[24:25], v52 offset:0
    ds_read_b64_tr_b16 v[26:27], v52 offset:1024
    v_mfma_f32_32x32x16_bf16 v[64:79], v[44:47], v[36:39], v[64:79]
    ds_read_b128 v[20:23], v51 offset:1024
    ds_read_b64_tr_b16 v[28:29], v52 offset:2048
    ds_read_b64_tr_b16 v[30:31], v52 offset:3072
    s_add_u32 m0, s9, 65536
    s_add_u32 s50, s10, 98304
    buffer_load_dwordx4 v49, s[24:27], s50 offen sc1 lds
    s_add_u32 m0, s49, 73728
    s_mov_b32 s50, 1572864
    buffer_load_dwordx4 v50, s[32:35], s50 offen lds
    s_waitcnt vmcnt(6) lgkmcnt(0)
    s_barrier
    v_mfma_f32_32x32x16_bf16 v[64:79], v[24:27], v[16:19], v[64:79]
    ds_read_b128 v[32:35], v51 offset:16384
    ds_read_b64_tr_b16 v[40:41], v52 offset:16384
    ds_read_b64_tr_b16 v[42:43], v52 offset:17408
    v_mfma_f32_32x32x16_bf16 v[64:79], v[28:31], v[20:23], v[64:79]
    ds_read_b128 v[36:39], v51 offset:17408
    ds_read_b64_tr_b16 v[44:45], v52 offset:18432
    ds_read_b64_tr_b16 v[46:47], v52 offset:19456
    s_add_u32 m0, s9, 0
    s_add_u32 s50, s10, 102400
    buffer_load_dwordx4 v49, s[24:27], s50 offen sc1 lds
    s_add_u32 m0, s49, 8192
    s_mov_b32 s50, 1638400
    buffer_load_dwordx4 v50, s[32:35], s50 offen lds
    s_waitcnt vmcnt(6) lgkmcnt(0)
    s_barrier
    v_mfma_f32_32x32x16_bf16 v[64:79], v[40:43], v[32:35], v[64:79]
    ds_read_b128 v[16:19], v51 offset:32768
    ds_read_b64_tr_b16 v[24:25], v52 offset:32768
    ds_read_b64_tr_b16 v[26:27], v52 offset:33792
    v_mfma_f32_32x32x16_bf16 v[64:79], v[44:47], v[36:39], v[64:79]
    ds_read_b128 v[20:23], v51 offset:33792
    ds_read_b64_tr_b16 v[28:29], v52 offset:34816
    ds_read_b64_tr_b16 v[30:31], v52 offset:35840
    s_add_u32 m0, s9, 16384
    s_add_u32 s50, s10, 106496
    buffer_load_dwordx4 v49, s[24:27], s50 offen sc1 lds
    s_add_u32 m0, s49, 24576
    s_mov_b32 s50, 1703936
    buffer_load_dwordx4 v50, s[32:35], s50 offen lds
    s_waitcnt vmcnt(6) lgkmcnt(0)
    s_barrier
    v_mfma_f32_32x32x16_bf16 v[64:79], v[24:27], v[16:19], v[64:79]
    ds_read_b128 v[32:35], v51 offset:49152
    ds_read_b64_tr_b16 v[40:41], v52 offset:49152
    ds_read_b64_tr_b16 v[42:43], v52 offset:50176
    v_mfma_f32_32x32x16_bf16 v[64:79], v[28:31], v[20:23], v[64:79]
    ds_read_b128 v[36:39], v51 offset:50176
    ds_read_b64_tr_b16 v[44:45], v52 offset:51200
    ds_read_b64_tr_b16 v[46:47], v52 offset:52224
    s_add_u32 m0, s9, 32768
    s_add_u32 s50, s10, 110592
    buffer_load_dwordx4 v49, s[24:27], s50 offen sc1 lds
    s_add_u32 m0, s49, 40960
    s_mov_b32 s50, 1769472
    buffer_load_dwordx4 v50, s[32:35], s50 offen lds
    s_waitcnt vmcnt(6) lgkmcnt(0)
    s_barrier
    v_mfma_f32_32x32x16_bf16 v[64:79], v[40:43], v[32:35], v[64:79]
    ds_read_b128 v[16:19], v53 offset:0
    ds_read_b64_tr_b16 v[24:25], v54 offset:0
    ds_read_b64_tr_b16 v[26:27], v54 offset:1024
    v_mfma_f32_32x32x16_bf16 v[64:79], v[44:47], v[36:39], v[64:79]
    ds_read_b128 v[20:23], v53 offset:1024
    ds_read_b64_tr_b16 v[28:29], v54 offset:2048
    ds_read_b64_tr_b16 v[30:31], v54 offset:3072
    s_waitcnt vmcnt(4) lgkmcnt(0)
    s_barrier
    v_mfma_f32_32x32x16_bf16 v[64:79], v[24:27], v[16:19], v[64:79]
    ds_read_b128 v[32:35], v51 offset:0
    ds_read_b64_tr_b16 v[40:41], v52 offset:0
    ds_read_b64_tr_b16 v[42:43], v52 offset:1024
    v_mfma_f32_32x32x16_bf16 v[64:79], v[28:31], v[20:23], v[64:79]
    ds_read_b128 v[36:39], v51 offset:1024
    ds_read_b64_tr_b16 v[44:45], v52 offset:2048
    ds_read_b64_tr_b16 v[46:47], v52 offset:3072
    s_waitcnt vmcnt(2) lgkmcnt(0)
    s_barrier
    v_mfma_f32_32x32x16_bf16 v[64:79], v[40:43], v[32:35], v[64:79]
    ds_read_b128 v[16:19], v51 offset:16384
    ds_read_b64_tr_b16 v[24:25], v52 offset:16384
    ds_read_b64_tr_b16 v[26:27], v52 offset:17408
    v_mfma_f32_32x32x16_bf16 v[64:79], v[44:47], v[36:39], v[64:79]
    ds_read_b128 v[20:23], v51 offset:17408
    ds_read_b64_tr_b16 v[28:29], v52 offset:18432
    ds_read_b64_tr_b16 v[30:31], v52 offset:19456
    s_waitcnt vmcnt(0) lgkmcnt(0)
    s_barrier
    v_mfma_f32_32x32x16_bf16 v[64:79], v[24:27], v[16:19], v[64:79]
    ds_read_b128 v[32:35], v51 offset:32768
    ds_read_b64_tr_b16 v[40:41], v52 offset:32768
    ds_read_b64_tr_b16 v[42:43], v52 offset:33792
    v_mfma_f32_32x32x16_bf16 v[64:79], v[28:31], v[20:23], v[64:79]
    ds_read_b128 v[36:39], v51 offset:33792
    ds_read_b64_tr_b16 v[44:45], v52 offset:34816
    ds_read_b64_tr_b16 v[46:47], v52 offset:35840
    s_waitcnt lgkmcnt(0)
    v_mfma_f32_32x32x16_bf16 v[64:79], v[40:43], v[32:35], v[64:79]
    v_mfma_f32_32x32x16_bf16 v[64:79], v[44:47], v[36:39], v[64:79]
    s_cmp_lg_u32 s3, 0
    s_cbranch_scc1 F_wait3
    s_setprio 3
    s_mov_b32 s66, 0x40000
F_pollo:
    buffer_load_dword v16, v63, s[24:27], s100 offen sc1
    s_waitcnt vmcnt(0)
    v_cmp_ne_u32 vcc, s48, v16
    s_nop 4
    s_cmp_eq_u64 vcc, 0
    s_cbranch_scc1 F_pollo_ok
    s_sleep 2
    s_sub_u32 s66, s66, 1
    s_cmp_lg_u32 s66, 0
    s_cbranch_scc1 F_pollo
F_pollo_ok:
F_wait3:
    s_setprio 3
    s_barrier
    s_add_u32 m0, s96, 0
    s_add_u32 s50, s97, 0
    buffer_load_dwordx4 v48, s[24:27], s50 offen sc1 lds
    s_add_u32 m0, s96, 2048
    s_add_u32 s50, s97, 2048
    buffer_load_dwordx4 v48, s[24:27], s50 offen sc1 lds
    s_add_u32 m0, s96, 4096
    s_add_u32 s50, s97, 4096
    buffer_load_dwordx4 v48, s[24:27], s50 offen sc1 lds
    s_add_u32 m0, s96, 6144
    s_add_u32 s50, s97, 6144
    buffer_load_dwordx4 v48, s[24:27], s50 offen sc1 lds
    s_add_u32 m0, s96, 8192
    s_add_u32 s50, s97, 8192
    buffer_load_dwordx4 v48, s[24:27], s50 offen sc1 lds
    s_add_u32 m0, s96, 10240
    s_add_u32 s50, s97, 10240
    buffer_load_dwordx4 v48, s[24:27], s50 offen sc1 lds
    s_add_u32 m0, s96, 12288
    s_add_u32 s50, s97, 12288
    buffer_load_dwordx4 v48, s[24:27], s50 offen sc1 lds
    s_add_u32 m0, s96, 14336
    s_add_u32 s50, s97, 14336
    buffer_load_dwordx4 v48, s[24:27], s50 offen sc1 lds
    v_sub_f32 v56, 1.0, v57
    v_mul_f32 v64, v56, v64
    v_mul_f32 v65, v56, v65
    v_mul_f32 v66, v56, v66
    v_mul_f32 v67, v56, v67
    v_mul_f32 v68, v56, v68
    v_mul_f32 v69, v56, v69
    v_mul_f32 v70, v56, v70
    v_mul_f32 v71, v56, v71
    v_mul_f32 v72, v56, v72
    v_mul_f32 v73, v56, v73
    v_mul_f32 v74, v56, v74
    v_mul_f32 v75, v56, v75
    v_mul_f32 v76, v56, v76
    v_mul_f32 v77, v56, v77
    v_mul_f32 v78, v56, v78
    v_mul_f32 v79, v56, v79
    s_waitcnt vmcnt(4)
    s_barrier
    ds_read_b128 v[32:35], v61 offset:0
    ds_read_b128 v[36:39], v61 offset:1024
    ds_read_b128 v[40:43], v61 offset:2048
    ds_read_b128 v[44:47], v61 offset:3072
    s_waitcnt lgkmcnt(3)
    v_mfma_f32_32x32x16_bf16 v[16:31], v[0:3], v[32:35], 0
    ds_read_b128 v[32:35], v61 offset:4096
    s_waitcnt lgkmcnt(3)
    v_mfma_f32_32x32x16_bf16 v[16:31], v[4:7], v[36:39], v[16:31]
    ds_read_b128 v[36:39], v61 offset:5120
    s_waitcnt lgkmcnt(3)
    v_mfma_f32_32x32x16_bf16 v[16:31], v[8:11], v[40:43], v[16:31]
    ds_read_b128 v[40:43], v61 offset:6144
    s_waitcnt lgkmcnt(3)
    v_mfma_f32_32x32x16_bf16 v[16:31], v[12:15], v[44:47], v[16:31]
    ds_read_b128 v[44:47], v61 offset:7168
    s_waitcnt lgkmcnt(3)
    v_mfma_f32_32x32x16_bf16 v[16:31], v[80:83], v[32:35], v[16:31]
    s_waitcnt lgkmcnt(2)
    v_mfma_f32_32x32x16_bf16 v[16:31], v[84:87], v[36:39], v[16:31]
    s_waitcnt lgkmcnt(1)
    v_mfma_f32_32x32x16_bf16 v[16:31], v[88:91], v[40:43], v[16:31]
    s_waitcnt lgkmcnt(0)
    v_mfma_f32_32x32x16_bf16 v[16:31], v[92:95], v[44:47], v[16:31]
    s_waitcnt vmcnt(0)
    s_barrier
    ds_read_b128 v[32:35], v61 offset:8192
    ds_read_b128 v[36:39], v61 offset:9216
    ds_read_b128 v[40:43], v61 offset:10240
    ds_read_b128 v[44:47], v61 offset:11264
    s_waitcnt lgkmcnt(3)
    v_mfma_f32_32x32x16_bf16 v[16:31], v[96:99], v[32:35], v[16:31]
    ds_read_b128 v[32:35], v61 offset:12288
    s_waitcnt lgkmcnt(3)
    v_mfma_f32_32x32x16_bf16 v[16:31], v[100:103], v[36:39], v[16:31]
    ds_read_b128 v[36:39], v61 offset:13312
    s_waitcnt lgkmcnt(3)
    v_mfma_f32_32x32x16_bf16 v[16:31], v[104:107], v[40:43], v[16:31]
    ds_read_b128 v[40:43], v61 offset:14336
    s_waitcnt lgkmcnt(3)
    v_mfma_f32_32x32x16_bf16 v[16:31], v[108:111], v[44:47], v[16:31]
    ds_read_b128 v[44:47], v61 offset:15360
    s_waitcnt lgkmcnt(3)
    v_mfma_f32_32x32x16_bf16 v[16:31], v[112:115], v[32:35], v[16:31]
    s_waitcnt lgkmcnt(2)
    v_mfma_f32_32x32x16_bf16 v[16:31], v[116:119], v[36:39], v[16:31]
    s_waitcnt lgkmcnt(1)
    v_mfma_f32_32x32x16_bf16 v[16:31], v[120:123], v[40:43], v[16:31]
    s_waitcnt lgkmcnt(0)
    v_mfma_f32_32x32x16_bf16 v[16:31], v[124:127], v[44:47], v[16:31]
    s_cmp_ge_u32 s3, 4
    s_cbranch_scc1 F_hi
    s_nop 9
    v_fmac_f32 v72, v57, v24
    v_fmac_f32 v73, v57, v25
    v_fmac_f32 v74, v57, v26
    v_fmac_f32 v75, v57, v27
    v_fmac_f32 v76, v57, v28
    v_fmac_f32 v77, v57, v29
    v_fmac_f32 v78, v57, v30
    v_fmac_f32 v79, v57, v31
    ds_write_b128 v59, v[72:75]
    ds_write_b128 v59, v[76:79] offset:1024
    v_fmac_f32 v64, v57, v16
    v_fmac_f32 v65, v57, v17
    v_fmac_f32 v66, v57, v18
    v_fmac_f32 v67, v57, v19
    v_fmac_f32 v68, v57, v20
    v_fmac_f32 v69, v57, v21
    v_fmac_f32 v70, v57, v22
    v_fmac_f32 v71, v57, v23
    s_waitcnt lgkmcnt(0)
    s_barrier
    ds_read_b128 v[20:23], v60
    ds_read_b128 v[24:27], v60 offset:1024
    s_waitcnt lgkmcnt(1)
    v_add_f32 v64, v64, v20
    v_add_f32 v65, v65, v21
    v_add_f32 v66, v66, v22
    v_add_f32 v67, v67, v23
    s_waitcnt lgkmcnt(0)
    v_add_f32 v68, v68, v24
    v_add_f32 v69, v69, v25
    v_add_f32 v70, v70, v26
    v_add_f32 v71, v71, v27
    v_cvt_pk_bf16_f32 v16, v64, v65
    v_cvt_pk_bf16_f32 v17, v66, v67
    v_cvt_pk_bf16_f32 v18, v68, v69
    v_cvt_pk_bf16_f32 v19, v70, v71
    s_branch F_x
F_hi:
    s_nop 9
    v_fmac_f32 v64, v57, v16
    v_fmac_f32 v65, v57, v17
    v_fmac_f32 v66, v57, v18
    v_fmac_f32 v67, v57, v19
    v_fmac_f32 v68, v57, v20
    v_fmac_f32 v69, v57, v21
    v_fmac_f32 v70, v57, v22
    v_fmac_f32 v71, v57, v23
    ds_write_b128 v59, v[64:67]
    ds_write_b128 v59, v[68:71] offset:1024
    v_fmac_f32 v72, v57, v24
    v_fmac_f32 v73, v57, v25
    v_fmac_f32 v74, v57, v26
    v_fmac_f32 v75, v57, v27
    v_fmac_f32 v76, v57, v28
    v_fmac_f32 v77, v57, v29
    v_fmac_f32 v78, v57, v30
    v_fmac_f32 v79, v57, v31
    s_waitcnt lgkmcnt(0)
    s_barrier
    ds_read_b128 v[20:23], v60
    ds_read_b128 v[24:27], v60 offset:1024
    s_waitcnt lgkmcnt(1)
    v_add_f32 v72, v72, v20
    v_add_f32 v73, v73, v21
    v_add_f32 v74, v74, v22
    v_add_f32 v75, v75, v23
    s_waitcnt lgkmcnt(0)
    v_add_f32 v76, v76, v24
    v_add_f32 v77, v77, v25
    v_add_f32 v78, v78, v26
    v_add_f32 v79, v79, v27
    v_cvt_pk_bf16_f32 v16, v72, v73
    v_cvt_pk_bf16_f32 v17, v74, v75
    v_cvt_pk_bf16_f32 v18, v76, v77
    v_cvt_pk_bf16_f32 v19, v78, v79
F_x:
    s_nop 1
    v_permlane32_swap_b32 v16, v18
    v_permlane32_swap_b32 v17, v19
    buffer_store_dwordx4 v[16:19], v58, s[40:43], s98 offen
    s_endpgm
CODE_END:
.section .rodata,"a"
.p2align 6
.amdhsa_kernel gated_mix__softmax_full_mha__swiglu_ffn__prompt_kernel
  .amdhsa_next_free_vgpr 128
  .amdhsa_next_free_sgpr 102
  .amdhsa_accum_offset 128
  .amdhsa_group_segment_fixed_size 0
  .amdhsa_kernarg_size 88
  .amdhsa_user_sgpr_count 2
  .amdhsa_user_sgpr_kernarg_segment_ptr 1
  .amdhsa_system_sgpr_workgroup_id_x 1
.end_amdhsa_kernel
```
